```python
import torch

def _softmax(x, axis=-1):
    return torch.softmax(x, dim=axis)
def _gelu(x):
    return torch.nn.functional.gelu(x, approximate="tanh")
def _silu(x):
    return torch.nn.functional.silu(x)
def _sigmoid(x):
    return torch.sigmoid(x)
def _layernorm(x, axis=-1, eps=1e-5):
    m = x.mean(dim=axis, keepdim=True)
    v = x.var(dim=axis, keepdim=True, unbiased=False)
    return (x - m) / torch.sqrt(v + eps)
def _scatter_add(tgt, idx, src, axis=0):
    return tgt.clone().index_add_(axis, idx, src)
def _segment_sum(src, seg, n):
    out = torch.zeros((n,) + src.shape[1:], dtype=src.dtype)
    return out.index_add_(0, seg, src)
def _pad(x, pw):
    flat = tuple(v for pair in reversed(pw) for v in pair)
    return torch.nn.functional.pad(x, flat)

kernel_name = 'gated_mix__linear_attn_block__glu_gated_reglu__prompt'

def setup_inputs():

    _w = (lambda a: (lambda t: t.to(torch.bfloat16) if t.is_floating_point() else t)(torch.as_tensor(a)))
    def _A_setup():
        B, S, D = 1, 2048, 448
        return {
            "x": _w((lambda *s: torch.randn(*s, dtype=torch.bfloat16) * 0.05)(B, S, D)),
            "wqkv": _w((lambda *s: torch.randn(*s, dtype=torch.bfloat16) * 0.8)(D, 3 * D)),
            "wo": _w((lambda *s: torch.randn(*s, dtype=torch.bfloat16) * 0.05)(D, D)),
        }
    _A_in = _A_setup()

    def _B_setup():
        B, S, D, F = 1, 2048, 448, 1792
        return {
            "x": _w((lambda *s: torch.randn(*s, dtype=torch.bfloat16) * 0.05)(B, S, D)),
            "W_gate": _w((lambda *s: torch.randn(*s, dtype=torch.bfloat16) * 1.6)(D, F) * (2.0 / D) ** 0.5),
            "W_up": _w((lambda *s: torch.randn(*s, dtype=torch.bfloat16) * 1.6)(D, F) * (2.0 / D) ** 0.5),
            "W_down": _w((lambda *s: torch.randn(*s, dtype=torch.bfloat16) * 1.6)(F, D) * (1.0 / F) ** 0.5),
        }
    _B_in = _B_setup()

    return {
        "A_x": _A_in["x"],
        "A_wqkv": _A_in["wqkv"],
        "A_wo": _A_in["wo"],
        "B_x": _B_in["x"],
        "B_W_gate": _B_in["W_gate"],
        "B_W_up": _B_in["W_up"],
        "B_W_down": _B_in["W_down"],
        "gate_w": _w((lambda *s: torch.randn(*s, dtype=torch.bfloat16) * 0.05)(448) * 16.0),
    }

def reference(A_x, A_wqkv, A_wo, B_x, B_W_gate, B_W_up, B_W_down, gate_w):
    def _A_ref(x, wqkv, wo):
        B, S, D = x.shape
        H = 16; Dh = D // H
        qkv = (lambda x, *d: x.permute(*d))((x @ wqkv).reshape(B, S, 3, H, Dh), 2, 0, 3, 1, 4)
        q, k, v = qkv[0], qkv[1], qkv[2]
        phi = lambda t: torch.where(t > 0, t + 1, torch.exp(t)) + 1e-6
        pq, pk = phi(q), phi(k)
        kv = torch.einsum("bhsd,bhse->bhde", pk, v)
        z = torch.einsum("bhsd->bhd", pk)
        num = torch.einsum("bhqd,bhde->bhqe", pq, kv)
        den = torch.einsum("bhqd,bhd->bhq", pq, z)[..., None] + 1e-6
        o = num / den
        return (lambda x, *d: x.permute(*d))(o, 0, 2, 1, 3).reshape(B, S, D) @ wo

    def _B_ref(x, W_gate, W_up, W_down):
        gate = torch.einsum("bsd,df->bsf", x, W_gate)
        up = torch.einsum("bsd,df->bsf", x, W_up)
        gate = gate * (lambda x, dt: x.to(dt))(gate > 0, gate.dtype)
        h = gate * up
        return torch.einsum("bsf,fd->bsd", h, W_down)

    x = A_x
    g = _sigmoid((x * gate_w).sum(-1, keepdims=True))
    a = _A_ref(x, A_wqkv, A_wo)
    b = _B_ref(x, B_W_gate, B_W_up, B_W_down)
    return g * a + (1 - g) * b
```

```asm
; @launch grid=(256,1,1) block=(256,1,1) lds=163840
.amdgcn_target "amdgcn-amd-amdhsa--gfx950"
.text
.globl gated_mix__linear_attn_block__glu_gated_reglu__prompt_kernel
.p2align 8
.type gated_mix__linear_attn_block__glu_gated_reglu__prompt_kernel,@function
gated_mix__linear_attn_block__glu_gated_reglu__prompt_kernel:
 s_cmp_ge_u32 s2, 256
 s_cbranch_scc1 L_end
 s_load_dwordx16 s[4:19], s[0:1], 0
 s_load_dwordx4 s[20:23], s[0:1], 64
 s_load_dwordx2 s[24:25], s[0:1], 80
 s_getpc_b64 s[68:69]
 s_lshr_b32 s76, s2, 3
 s_mul_i32 s3, s76, 9
 v_min_u32 v36, 8, v0
 v_add_lshl_u32 v36, v36, s3, 7
 v_min_u32 v36, L_code_end-gated_mix__linear_attn_block__glu_gated_reglu__prompt_kernel-64, v36
 v_add_co_u32 v36, vcc, s68, v36
 v_mov_b32 v37, s69
 s_mov_b32 s71, 0x20000
 v_addc_co_u32 v37, vcc, 0, v37, vcc
 global_load_dword v34, v[36:37], off
 v_lshrrev_b32 v51, 6, v0
 v_and_b32 v1, 63, v0
 v_readfirstlane_b32 s72, v51
 v_lshrrev_b32 v48, 3, v1
 v_and_b32 v49, 7, v0
 s_and_b32 s86, s76, 7
 s_lshr_b32 s78, s2, 6
 s_and_b32 s73, s2, 4
 s_lshl1_add_u32 s73, s73, s86
 s_lshl2_add_u32 s85, s73, s72
 s_mulk_i32 s85, 28672
 s_movk_i32 s87, 896
 v_xor_b32 v52, v49, v48
 v_lshl_add_u32 v52, v52, 4, s85
 v_mad_u32_u24 v80, v48, s87, v52
 s_movk_i32 s85, 6144
 v_add_u32 v81, s85, v80
 v_add_u32 v82, s85, v81
 v_add_u32 v83, s85, v82
 s_lshl_b32 s81, s72, 11
 s_lshl_b32 s82, s72, 12
 s_mov_b32 s30, 1835008
 s_mov_b32 s31, s71
 s_mov_b32 s34, 1204224
 s_mov_b32 s35, s71
 v_lshrrev_b32 v50, 2, v0
 v_and_b32 v50, 4, v50
 v_xor_b32 v50, v50, v49
 v_lshlrev_b32 v50, 4, v50
 s_lshr_b32 s77, s2, 1
 s_and_b32 s77, s77, 1
 s_xor_b32 s3, s86, s2
 s_and_b32 s3, s3, 1
 s_and_b32 s74, s2, 1
 s_lshl2_add_u32 s74, s74, s78
 s_cmp_eq_u32 s78, 3
 s_cselect_b32 s3, s3, 0
 s_cselect_b32 s74, 3, s74
 s_mul_i32 s85, s77, 7
 s_add_u32 s74, s74, s85
 s_mov_b32 s92, 0x38c217b0
 s_mov_b32 s93, 0xa6549d
 s_lshl_b32 s85, s74, 2
 s_lshr_b64 s[92:93], s[92:93], s85
 s_and_b32 s95, s92, 15
 s_add_u32 s85, s95, 7
 s_lshl_b32 s85, s85, 7
 s_movk_i32 s87, 2688
 v_lshl_add_u32 v51, v51, 4, v48
 v_add_u32 v52, s85, v50
 v_mad_u32_u24 v6, v51, s87, v52
 v_xor_b32 v7, 32, v6
 v_add_u32 v7, 20480, v7
 s_and_b32 s94, s2, 3
 s_lshl_b32 s94, s94, 8
 s_mov_b32 s26, s94
 s_mov_b32 m0, s82
 s_cmp_eq_u32 s3, 1
 s_waitcnt lgkmcnt(0)
 s_mov_b64 s[28:29], s[4:5]
 s_mov_b64 s[32:33], s[6:7]
 buffer_load_dwordx4 v80, s[28:31], s94 offen offset:0 lds
 buffer_load_dwordx4 v81, s[28:31], s94 offen offset:1024 lds
 buffer_load_dwordx4 v82, s[28:31], s94 offen offset:2048 lds
 buffer_load_dwordx4 v83, s[28:31], s94 offen offset:3072 lds
 s_cbranch_scc1 L_t3
 s_add_u32 m0, s81, 65536
 s_mul_i32 s84, s26, 1344
 buffer_load_dwordx4 v6, s[32:35], s84 offen offset:0 lds
 buffer_load_dwordx4 v7, s[32:35], s84 offen offset:1024 lds
 s_lshl2_add_u32 s85, s2, s72
 s_mul_i32 s85, s85, 10
 v_min_u32 v16, 9, v1
 v_add_lshl_u32 v16, v16, s85, 7
 buffer_load_dword v68, v16, s[32:35], 0 offen
 v_lshlrev_b32 v2, 4, v1
 v_lshlrev_b32 v3, 2, v1
 s_and_b32 s79, s2, 63
 s_lshl_b32 s80, s72, 10
 s_bfe_u32 s86, s2, 0x20004
 s_add_u32 s86, s86, 24
 s_cmp_eq_u32 s78, 3
 s_cselect_b32 s76, s86, s76
 s_mov_b32 s44, s24
 s_mov_b32 s45, s25
 s_mov_b32 s46, 13312000
 s_mov_b32 s47, 0x20000
 v_mov_b32 v40, 0
 v_mov_b32 v41, 0
 v_mov_b32 v42, 0
 v_mov_b32 v43, 0
 s_sub_u32 s97, s76, 24
 s_and_b32 s85, s2, 7
 s_lshl3_add_u32 s97, s97, s85
 s_lshl2_add_u32 s85, s97, s72
 s_lshl_b32 s85, s85, 10
 s_add_u32 s85, s85, 13246464
 s_cmp_lt_u32 s97, 16
 s_cselect_b32 s85, s85, s46
 v_add_u32 v44, s85, v2
 buffer_store_dwordx4 v[40:43], v44, s[44:47], 0 offen sc1
 v_lshrrev_b32 v54, 5, v1
 v_bfe_u32 v53, v1, 2, 2
 v_lshlrev_b32 v53, 7, v53
 v_and_b32 v52, 3, v1
 v_lshl_add_u32 v53, v52, 3, v53
 v_bfe_u32 v52, v1, 3, 1
 v_lshl_add_u32 v53, v52, 6, v53
 v_bfe_u32 v55, v1, 4, 1
 v_lshl_add_u32 v53, v55, 5, v53
 v_and_b32 v56, 31, v1
 v_mov_b32 v12, 0x3f803f80
 s_mov_b32 s48, s22
 s_mov_b32 s49, s23
 s_mov_b32 s50, 256
 s_mov_b32 s51, 0x20000
 v_lshrrev_b32 v57, 4, v1
 v_xor_b32 v52, v49, v57
 v_and_b32 v51, 15, v1
 v_lshlrev_b32 v51, 7, v51
 v_lshl_add_u32 v51, v52, 4, v51
 s_and_b32 s85, s82, 8192
 v_add_u32 v17, s85, v51
 v_xor_b32 v18, 64, v17
 s_and_b32 s85, s72, 1
 s_lshl_b32 s85, s85, 6
 v_xor_b32 v51, s85, v53
 v_lshl_add_u32 v21, v57, 11, v51
 v_lshl_add_u32 v10, v57, 10, v51
 v_add_u32 v10, 65536, v10
 v_xor_b32 v11, 32, v10
 s_cmp_lt_u32 s95, 7
 s_cselect_b32 s85, 0x358637bd, 0
 v_mov_b32 v92, s85
 v_mov_b32 v93, s85
 v_mov_b32 v94, s85
 v_mov_b32 v95, s85
 s_bitcmp0_b32 s78, 0
 s_cbranch_scc0 L_ts2
 s_lshl_b32 s10, s73, 1
 s_lshr_b32 s85, s72, 1
 s_add_u32 s10, s10, s85
 s_mul_i32 s85, s10, 50176
 s_and_b32 s10, s2, 3
 s_mul_i32 s10, s10, 7
 s_lshr_b32 s10, s10, 1
 s_lshl_b32 s10, s10, 8
 s_add_u32 s85, s85, s10
 s_mul_i32 s10, s78, 64
 s_add_u32 s85, s85, s10
 s_and_b32 s10, s2, 1
 s_add_u32 s87, 2, s10
 s_bitcmp1_b32 s72, 0
 s_cselect_b32 s68, s14, s12
 s_cselect_b32 s69, s15, s13
 s_mov_b32 s70, 1605632
 s_movk_i32 s4, 3584
 s_movk_i32 s5, 256
 s_movk_i32 s86, 2
 s_movk_i32 s88, 13
 s_branch L_tx2
L_ts2:
 s_lshr_b32 s10, s79, 4
 s_and_b32 s85, s2, 7
 s_lshl3_add_u32 s10, s10, s85
 s_cmp_eq_u32 s78, 1
 s_cselect_b32 s10, s79, s10
 s_lshl2_add_u32 s10, s10, s72
 s_cmp_eq_u32 s78, 1
 s_cselect_b32 s87, 49, 25
 s_cselect_b32 s68, s16, s8
 s_cselect_b32 s69, s17, s9
 s_mov_b32 s70, 401408
 s_movk_i32 s4, 0
 s_movk_i32 s5, 128
 s_movk_i32 s86, 6
 s_movk_i32 s88, 0
 s_cselect_b32 s70, 1605632, s70
 s_mul_i32 s85, s10, s87
 s_lshl_b32 s85, s85, 7
 s_sub_u32 s87, s87, 1
L_tx2:
 v_lshrrev_b32 v51, s86, v1
 v_bfe_u32 v52, v1, 0, s86
 v_min_u32 v51, s88, v51
 v_min_u32 v52, s87, v52
 v_mul_u32_u24 v16, s4, v51
 v_mad_u32_u24 v16, v52, s5, v16
 v_add_u32 v16, s85, v16
 s_sub_u32 s40, s14, 1024
 s_subb_u32 s41, s15, 0
 s_mul_i32 s0, s72, 28672
 s_lshl_b32 s1, s74, 8
 s_add_u32 s0, s0, s1
 v_mul_u32_u24 v51, 3584, v48
 v_add3_u32 v4, v51, v50, s0
 s_and_b32 s0, s72, 1
 s_lshl_b32 s0, s0, 5
 v_xor_b32 v4, s0, v4
 s_mov_b32 s36, s12
 s_mov_b32 s37, s13
 s_mov_b32 s38, 1605632
 s_mov_b32 s39, 0x20000
 s_mov_b32 s42, 1606656
 s_mov_b32 s43, 0x20000
 v_xor_b32 v22, 32, v21
 v_add_u32 v25, 65536, v21
 v_add_u32 v26, 65536, v22
 v_add_u32 v29, 131072, v21
 v_add_u32 v30, 131072, v22
 v_and_b32 v33, 124, v3
 s_mov_b32 s89, 0x358637bd
 v_mov_b32 v91, 0xb5c1a2a0
 s_lshr_b32 s0, s72, 1
 s_lshl_b32 s1, s73, 1
 s_add_u32 s0, s0, s1
 s_mul_i32 s0, s0, 144
 s_and_b32 s1, s74, 1
 s_mul_i32 s1, s1, 35
 s_add_u32 s1, s1, s74
 s_add_u32 s0, s0, s1
 s_lshl_b32 s0, s0, 1
 s_and_b32 s1, s72, 1
 s_mul_i32 s1, s1, 144
 s_add_u32 s0, s0, s1
 s_lshl_b32 s0, s0, 10
 v_and_b32 v8, 240, v2
 v_lshl_add_u32 v8, v55, 9, v8
 v_lshl_add_u32 v8, v54, 11, v8
 v_add_u32 v8, s0, v8
 s_lshl4_add_u32 s0, s73, s74
 s_lshl_b32 s0, s0, 7
 s_add_u32 s27, s0, 13246464
 v_mov_b32 v15, 1
 s_and_b32 s96, s73, 3
 s_add_u32 s1, s95, 1
 s_lshr_b32 s1, s1, 3
 s_xor_b32 s0, s1, 1
 s_mul_i32 s98, s0, 0x3f800000
 s_mul_i32 s0, s0, 0x358637bd
 s_mul_i32 s1, s1, 0xff800000
 s_add_u32 s91, s0, s1
 s_lshr_b32 s0, s72, 1
 s_lshl1_add_u32 s0, s73, s0
 s_lshl_b32 s0, s0, 10
 s_and_b32 s1, s72, 1
 s_lshl1_add_u32 s1, s95, s1
 s_mul_i32 s1, s1, 133120
 s_add_u32 s0, s0, s1
 s_add_u32 s0, s0, 9437184
 s_add_u32 m0, s82, 16384
 s_addk_i32 s26, 128
 s_cmpk_eq_u32 s26, 896
 s_cselect_b32 s26, 0, s26
 buffer_load_dwordx4 v80, s[28:31], s26 offen offset:0 lds
 buffer_load_dwordx4 v81, s[28:31], s26 offen offset:1024 lds
 buffer_load_dwordx4 v82, s[28:31], s26 offen offset:2048 lds
 buffer_load_dwordx4 v83, s[28:31], s26 offen offset:3072 lds
 s_add_u32 m0, s81, 73728
 s_mul_i32 s84, s26, 1344
 buffer_load_dwordx4 v6, s[32:35], s84 offen offset:0 lds
 buffer_load_dwordx4 v7, s[32:35], s84 offen offset:1024 lds
 s_add_u32 m0, s82, 32768
 s_addk_i32 s26, 128
 s_cmpk_eq_u32 s26, 896
 s_cselect_b32 s26, 0, s26
 buffer_load_dwordx4 v80, s[28:31], s26 offen offset:0 lds
 buffer_load_dwordx4 v81, s[28:31], s26 offen offset:1024 lds
 buffer_load_dwordx4 v82, s[28:31], s26 offen offset:2048 lds
 buffer_load_dwordx4 v83, s[28:31], s26 offen offset:3072 lds
 s_waitcnt vmcnt(12)
 s_barrier
 ds_read_b128 a[0:3], v17 offset:0
 ds_read_b128 a[4:7], v17 offset:2048
 ds_read_b128 a[8:11], v17 offset:4096
 ds_read_b128 a[12:15], v17 offset:6144
 ds_read_b64_tr_b16 a[224:225], v10 offset:0
 ds_read_b64_tr_b16 a[226:227], v10 offset:512
 ds_read_b64_tr_b16 a[228:229], v11 offset:0
 ds_read_b64_tr_b16 a[230:231], v11 offset:512
 ds_read_b128 a[16:19], v18 offset:0
 ds_read_b128 a[20:23], v18 offset:2048
 ds_read_b128 a[24:27], v18 offset:4096
 ds_read_b128 a[28:31], v18 offset:6144
 s_waitcnt lgkmcnt(6)
 v_mfma_f32_16x16x32_bf16 v[96:99], a[0:3], a[224:227], v[92:95]
 ds_read_b64_tr_b16 a[232:233], v10 offset:4096
 ds_read_b64_tr_b16 a[234:235], v10 offset:4608
 s_add_u32 m0, s81, 81920
 s_mul_i32 s84, s26, 1344
 v_mfma_f32_16x16x32_bf16 v[100:103], a[4:7], a[224:227], v[92:95]
 buffer_load_dwordx4 v6, s[32:35], s84 offen offset:0 lds
 v_and_b32 v51, 1, v48
 v_mul_u32_u24 v9, 33280, v51
 v_lshl_add_u32 v9, v57, 7, v9
 v_mfma_f32_16x16x32_bf16 v[104:107], a[8:11], a[224:227], v[92:95]
 buffer_load_dwordx4 v7, s[32:35], s84 offen offset:1024 lds
 v_lshl_add_u32 v9, v49, 4, v9
 v_add_u32 v9, s0, v9
 s_and_b32 s75, s2, 7
 v_mfma_f32_16x16x32_bf16 v[108:111], a[12:15], a[224:227], v[92:95]
 s_add_u32 m0, s82, 49152
 s_addk_i32 s26, 128
 s_cmpk_eq_u32 s26, 896
 s_cselect_b32 s26, 0, s26
 s_waitcnt lgkmcnt(6)
 v_mfma_f32_16x16x32_bf16 v[112:115], a[0:3], a[228:231], v[92:95]
 buffer_load_dwordx4 v80, s[28:31], s26 offen offset:0 lds
 ds_read_b64_tr_b16 a[236:237], v11 offset:4096
 ds_read_b64_tr_b16 a[238:239], v11 offset:4608
 s_lshl_b32 s75, s75, 2
 v_mfma_f32_16x16x32_bf16 v[116:119], a[4:7], a[228:231], v[92:95]
 buffer_load_dwordx4 v81, s[28:31], s26 offen offset:1024 lds
 s_and_b32 s1, s76, 3
 s_add_u32 s75, s75, s1
 s_lshr_b32 s76, s76, 2
 v_mfma_f32_16x16x32_bf16 v[120:123], a[8:11], a[228:231], v[92:95]
 buffer_load_dwordx4 v82, s[28:31], s26 offen offset:2048 lds
 s_mov_b32 s52, s16
 s_mov_b32 s53, s17
 s_mov_b32 s54, 1605632
 v_mfma_f32_16x16x32_bf16 v[124:127], a[12:15], a[228:231], v[92:95]
 buffer_load_dwordx4 v83, s[28:31], s26 offen offset:3072 lds
 s_mov_b32 s55, 0x20000
 s_mov_b32 s56, s8
 s_waitcnt lgkmcnt(2)
 v_mfma_f32_16x16x32_bf16 v[96:99], a[16:19], a[232:235], v[96:99]
 s_add_u32 m0, s81, 90112
 s_mul_i32 s84, s26, 1344
 buffer_load_dwordx4 v6, s[32:35], s84 offen offset:0 lds
 s_waitcnt vmcnt(11)
 s_barrier
 ds_read_b128 a[32:35], v17 offset:16384
 ds_read_b128 a[36:39], v17 offset:18432
 v_mfma_f32_16x16x32_bf16 v[100:103], a[20:23], a[232:235], v[100:103]
 buffer_load_dwordx4 v7, s[32:35], s84 offen offset:1024 lds
 ds_read_b128 a[40:43], v17 offset:20480
 ds_read_b128 a[44:47], v17 offset:22528
 s_mov_b32 s57, s9
 v_mfma_f32_16x16x32_bf16 v[104:107], a[24:27], a[232:235], v[104:107]
 ds_read_b64_tr_b16 a[240:241], v10 offset:8192
 ds_read_b64_tr_b16 a[242:243], v10 offset:8704
 s_add_u32 m0, s82, 0
 s_addk_i32 s26, 128
 s_cmpk_eq_u32 s26, 896
 s_cselect_b32 s26, 0, s26
 v_mfma_f32_16x16x32_bf16 v[108:111], a[28:31], a[232:235], v[108:111]
 buffer_load_dwordx4 v80, s[28:31], s26 offen offset:0 lds
 s_mov_b32 s58, 401408
 s_mov_b32 s59, 0x20000
 s_waitcnt lgkmcnt(6)
 v_mfma_f32_16x16x32_bf16 v[112:115], a[16:19], a[236:239], v[112:115]
 buffer_load_dwordx4 v81, s[28:31], s26 offen offset:1024 lds
 ds_read_b64_tr_b16 a[244:245], v11 offset:8192
 ds_read_b64_tr_b16 a[246:247], v11 offset:8704
 s_mov_b32 s60, s20
 v_mfma_f32_16x16x32_bf16 v[116:119], a[20:23], a[236:239], v[116:119]
 buffer_load_dwordx4 v82, s[28:31], s26 offen offset:2048 lds
 ds_read_b128 a[48:51], v18 offset:16384
 ds_read_b128 a[52:55], v18 offset:18432
 s_mov_b32 s61, s21
 v_mfma_f32_16x16x32_bf16 v[120:123], a[24:27], a[236:239], v[120:123]
 buffer_load_dwordx4 v83, s[28:31], s26 offen offset:3072 lds
 ds_read_b128 a[56:59], v18 offset:20480
 ds_read_b128 a[60:63], v18 offset:22528
 s_mov_b32 s62, 1835008
 v_mfma_f32_16x16x32_bf16 v[124:127], a[28:31], a[236:239], v[124:127]
 s_add_u32 m0, s81, 98304
 s_mul_i32 s84, s26, 1344
 s_mov_b32 s63, 0x20000
 s_waitcnt lgkmcnt(6)
 v_mfma_f32_16x16x32_bf16 v[96:99], a[32:35], a[240:243], v[96:99]
 buffer_load_dwordx4 v6, s[32:35], s84 offen offset:0 lds
 ds_read_b64_tr_b16 a[248:249], v10 offset:12288
 ds_read_b64_tr_b16 a[250:251], v10 offset:12800
 s_and_b32 s1, s72, 1
 v_mfma_f32_16x16x32_bf16 v[100:103], a[36:39], a[240:243], v[100:103]
 buffer_load_dwordx4 v7, s[32:35], s84 offen offset:1024 lds
 s_lshl_b32 s1, s1, 2
 s_lshr_b32 s3, s72, 1
 s_add_u32 s1, s1, s3
 v_mfma_f32_16x16x32_bf16 v[104:107], a[40:43], a[240:243], v[104:107]
 s_mul_i32 s1, s1, 28672
 s_mul_i32 s3, s72, 100352
 s_sub_u32 s11, s3, s1
 s_lshl_b32 s0, s76, 7
 v_mfma_f32_16x16x32_bf16 v[108:111], a[44:47], a[240:243], v[108:111]
 s_add_u32 s1, s1, s0
 v_mul_u32_u24 v51, 896, v48
 v_add3_u32 v60, v51, v50, s1
 s_waitcnt lgkmcnt(6)
 v_mfma_f32_16x16x32_bf16 v[112:115], a[32:35], a[244:247], v[112:115]
 ds_read_b64_tr_b16 a[252:253], v11 offset:12288
 ds_read_b64_tr_b16 a[254:255], v11 offset:12800
 v_add_u32 v61, 13312, v60
 s_lshl_b32 s0, s75, 2
 v_mfma_f32_16x16x32_bf16 v[116:119], a[36:39], a[244:247], v[116:119]
 s_add_u32 s0, s0, s72
 s_mul_i32 s0, s0, 72
 s_lshr_b32 s1, s72, 1
 s_add_u32 s0, s0, s1
 v_mfma_f32_16x16x32_bf16 v[120:123], a[40:43], a[244:247], v[120:123]
 s_lshl_b32 s0, s0, 10
 v_add_u32 v62, s0, v2
 v_xor_b32 v63, 1024, v62
 v_lshl_add_u32 v51, v54, 9, v53
 v_mfma_f32_16x16x32_bf16 v[124:127], a[44:47], a[244:247], v[124:127]
 s_and_b32 s0, s72, 1
 s_lshl_b32 s0, s0, 6
 v_xor_b32 v51, s0, v51
 s_waitcnt lgkmcnt(2)
 v_mfma_f32_16x16x32_bf16 v[96:99], a[48:51], a[248:251], v[96:99]
 s_waitcnt vmcnt(12)
 s_barrier
 s_or_b32 s85, s97, s80
 s_cmp_lt_u32 s85, 16
 s_cbranch_scc0 L_noflag
 s_lshl_b32 s85, s85, 2
 s_mov_b64 exec, 1
 buffer_store_dword v12, off, s[48:51], s85 sc1
 s_mov_b64 exec, -1
L_noflag:
 s_bitcmp1_b32 1, s78
 s_cbranch_scc0 L_tch2
 buffer_load_dword v16, v16, s[68:71], 0 offen
L_tch2:
 ds_read_b128 a[64:67], v17 offset:32768
 ds_read_b128 a[68:71], v17 offset:34816
 v_mfma_f32_16x16x32_bf16 v[100:103], a[52:55], a[248:251], v[100:103]
 ds_read_b128 a[72:75], v17 offset:36864
 ds_read_b128 a[76:79], v17 offset:38912
 s_add_u32 m0, s82, 16384
 s_addk_i32 s26, 128
 s_cmpk_eq_u32 s26, 896
 s_cselect_b32 s26, 0, s26
 v_mfma_f32_16x16x32_bf16 v[104:107], a[56:59], a[248:251], v[104:107]
 buffer_load_dwordx4 v80, s[28:31], s26 offen offset:0 lds
 ds_read_b64_tr_b16 a[224:225], v10 offset:16384
 ds_read_b64_tr_b16 a[226:227], v10 offset:16896
 v_add_u32 v69, s81, v51
 v_mfma_f32_16x16x32_bf16 v[108:111], a[60:63], a[248:251], v[108:111]
 buffer_load_dwordx4 v81, s[28:31], s26 offen offset:1024 lds
 v_xor_b32 v70, 64, v69
 v_add_u32 v71, 0x10000, v69
 s_waitcnt lgkmcnt(6)
 v_mfma_f32_16x16x32_bf16 v[112:115], a[48:51], a[252:255], v[112:115]
 buffer_load_dwordx4 v82, s[28:31], s26 offen offset:2048 lds
 ds_read_b64_tr_b16 a[228:229], v11 offset:16384
 ds_read_b64_tr_b16 a[230:231], v11 offset:16896
 v_add_u32 v72, 0x10000, v70
 v_mfma_f32_16x16x32_bf16 v[116:119], a[52:55], a[252:255], v[116:119]
 buffer_load_dwordx4 v83, s[28:31], s26 offen offset:3072 lds
 ds_read_b128 a[80:83], v18 offset:32768
 ds_read_b128 a[84:87], v18 offset:34816
 v_add_u32 v73, 0x20000, v69
 v_mfma_f32_16x16x32_bf16 v[120:123], a[56:59], a[252:255], v[120:123]
 ds_read_b128 a[88:91], v18 offset:36864
 ds_read_b128 a[92:95], v18 offset:38912
 s_add_u32 m0, s81, 65536
 s_mul_i32 s84, s26, 1344
 v_mfma_f32_16x16x32_bf16 v[124:127], a[60:63], a[252:255], v[124:127]
 buffer_load_dwordx4 v6, s[32:35], s84 offen offset:0 lds
 v_add_u32 v74, 0x20000, v70
 s_lshl_b32 s1, s75, 1
 s_waitcnt lgkmcnt(6)
 v_mfma_f32_16x16x32_bf16 v[96:99], a[64:67], a[224:227], v[96:99]
 buffer_load_dwordx4 v7, s[32:35], s84 offen offset:1024 lds
 ds_read_b64_tr_b16 a[232:233], v10 offset:20480
 ds_read_b64_tr_b16 a[234:235], v10 offset:20992
 s_lshr_b32 s3, s72, 1
 v_mfma_f32_16x16x32_bf16 v[100:103], a[68:71], a[224:227], v[100:103]
 s_add_u32 s1, s1, s3
 s_lshl_b32 s1, s1, 5
 v_add_u32 v51, s1, v56
 v_lshlrev_b32 v64, 2, v51
 v_mfma_f32_16x16x32_bf16 v[104:107], a[72:75], a[224:227], v[104:107]
 s_lshl_b32 s3, s3, 13
 s_add_u32 s3, s3, 13230080
 v_add_u32 v64, s3, v64
 v_lshlrev_b32 v65, 7, v54
 v_mfma_f32_16x16x32_bf16 v[108:111], a[76:79], a[224:227], v[108:111]
 v_xor_b32 v64, v65, v64
 v_and_b32 v52, 1, v51
 v_and_b32 v51, -2, v51
 s_waitcnt lgkmcnt(6)
 v_mfma_f32_16x16x32_bf16 v[112:115], a[64:67], a[228:231], v[112:115]
 ds_read_b64_tr_b16 a[236:237], v11 offset:20480
 ds_read_b64_tr_b16 a[238:239], v11 offset:20992
 v_mul_u32_u24 v66, 896, v51
 v_lshl_add_u32 v66, v54, 5, v66
 v_mfma_f32_16x16x32_bf16 v[116:119], a[68:71], a[228:231], v[116:119]
 v_lshl_add_u32 v66, v52, 4, v66
 s_lshl_b32 s1, s76, 7
 s_add_u32 s1, s1, s0
 v_add_u32 v66, s1, v66
 v_mfma_f32_16x16x32_bf16 v[120:123], a[72:75], a[228:231], v[120:123]
 v_add_u32 v67, s81, v2
 v_xor_b32 v75, 2048, v67
 v_xor_b32 v76, 4096, v67
 v_xor_b32 v77, 6144, v67
 v_mfma_f32_16x16x32_bf16 v[124:127], a[76:79], a[228:231], v[124:127]
 s_lshr_b32 s0, s75, 1
 s_and_b32 s1, s72, 1
 s_lshl4_add_u32 s1, s0, s1
 s_waitcnt lgkmcnt(2)
 v_mfma_f32_16x16x32_bf16 v[96:99], a[80:83], a[232:235], v[96:99]
 s_waitcnt vmcnt(12)
 s_barrier
 ds_read_b128 a[96:99], v17 offset:49152
 ds_read_b128 a[100:103], v17 offset:51200
 v_mfma_f32_16x16x32_bf16 v[100:103], a[84:87], a[232:235], v[100:103]
 ds_read_b128 a[104:107], v17 offset:53248
 ds_read_b128 a[108:111], v17 offset:55296
 s_add_u32 m0, s82, 32768
 s_addk_i32 s26, 128
 s_cmpk_eq_u32 s26, 896
 s_cselect_b32 s26, 0, s26
 v_mfma_f32_16x16x32_bf16 v[104:107], a[88:91], a[232:235], v[104:107]
 buffer_load_dwordx4 v80, s[28:31], s26 offen offset:0 lds
 ds_read_b64_tr_b16 a[240:241], v10 offset:24576
 ds_read_b64_tr_b16 a[242:243], v10 offset:25088
 s_lshl_b32 s1, s1, 7
 v_mfma_f32_16x16x32_bf16 v[108:111], a[92:95], a[232:235], v[108:111]
 buffer_load_dwordx4 v81, s[28:31], s26 offen offset:1024 lds
 s_add_u32 s1, s1, 13246464
 v_min_u32 v51, 6, v1
 s_waitcnt lgkmcnt(6)
 v_mfma_f32_16x16x32_bf16 v[112:115], a[80:83], a[236:239], v[112:115]
 buffer_load_dwordx4 v82, s[28:31], s26 offen offset:2048 lds
 ds_read_b64_tr_b16 a[244:245], v11 offset:24576
 ds_read_b64_tr_b16 a[246:247], v11 offset:25088
 v_lshl_add_u32 v78, v51, 8, s1
 v_mfma_f32_16x16x32_bf16 v[116:119], a[84:87], a[236:239], v[116:119]
 buffer_load_dwordx4 v83, s[28:31], s26 offen offset:3072 lds
 ds_read_b128 a[112:115], v18 offset:49152
 ds_read_b128 a[116:119], v18 offset:51200
 s_lshr_b32 s1, s72, 1
 v_mfma_f32_16x16x32_bf16 v[120:123], a[88:91], a[236:239], v[120:123]
 ds_read_b128 a[120:123], v18 offset:53248
 ds_read_b128 a[124:127], v18 offset:55296
 s_add_u32 m0, s81, 73728
 s_mul_i32 s84, s26, 1344
 v_mfma_f32_16x16x32_bf16 v[124:127], a[92:95], a[236:239], v[124:127]
 buffer_load_dwordx4 v6, s[32:35], s84 offen offset:0 lds
 s_lshl1_add_u32 s0, s0, s1
 s_and_b32 s1, s75, 1
 s_waitcnt lgkmcnt(6)
 v_mfma_f32_16x16x32_bf16 v[96:99], a[96:99], a[240:243], v[96:99]
 buffer_load_dwordx4 v7, s[32:35], s84 offen offset:1024 lds
 ds_read_b64_tr_b16 a[248:249], v10 offset:28672
 ds_read_b64_tr_b16 a[250:251], v10 offset:29184
 s_lshl1_add_u32 s0, s0, s1
 v_mfma_f32_16x16x32_bf16 v[100:103], a[100:103], a[240:243], v[100:103]
 s_lshl_b32 s0, s0, 8
 s_add_u32 s0, s0, 13295616
 v_and_b32 v52, 1, v1
 v_lshl_add_u32 v79, v52, 7, s0
 v_mfma_f32_16x16x32_bf16 v[104:107], a[104:107], a[240:243], v[104:107]
 v_mfma_f32_16x16x32_bf16 v[108:111], a[108:111], a[240:243], v[108:111]
 s_waitcnt lgkmcnt(6)
 v_mfma_f32_16x16x32_bf16 v[112:115], a[96:99], a[244:247], v[112:115]
 ds_read_b64_tr_b16 a[252:253], v11 offset:28672
 ds_read_b64_tr_b16 a[254:255], v11 offset:29184
 v_mfma_f32_16x16x32_bf16 v[116:119], a[100:103], a[244:247], v[116:119]
 v_mfma_f32_16x16x32_bf16 v[120:123], a[104:107], a[244:247], v[120:123]
 v_mfma_f32_16x16x32_bf16 v[124:127], a[108:111], a[244:247], v[124:127]
 s_waitcnt lgkmcnt(2)
 v_mfma_f32_16x16x32_bf16 v[96:99], a[112:115], a[248:251], v[96:99]
 s_waitcnt vmcnt(12)
 s_barrier
 s_bitcmp1_b32 2, s78
 s_cbranch_scc0 L_tch4
 buffer_load_dword v16, v16, s[68:71], 0 offen
L_tch4:
 ds_read_b128 a[128:131], v17 offset:0
 ds_read_b128 a[132:135], v17 offset:2048
 v_mfma_f32_16x16x32_bf16 v[100:103], a[116:119], a[248:251], v[100:103]
 ds_read_b128 a[136:139], v17 offset:4096
 ds_read_b128 a[140:143], v17 offset:6144
 s_add_u32 m0, s81, 106496
 v_mfma_f32_16x16x32_bf16 v[104:107], a[120:123], a[248:251], v[104:107]
 ds_read_b64_tr_b16 a[224:225], v10 offset:32768
 ds_read_b64_tr_b16 a[226:227], v10 offset:33280
 s_mul_i32 s83, s94, 1792
 v_mfma_f32_16x16x32_bf16 v[108:111], a[124:127], a[248:251], v[108:111]
 buffer_load_dwordx4 v4, s[36:39], s83 offen offset:0 lds
 s_waitcnt lgkmcnt(6)
 v_mfma_f32_16x16x32_bf16 v[112:115], a[112:115], a[252:255], v[112:115]
 ds_read_b64_tr_b16 a[228:229], v11 offset:32768
 ds_read_b64_tr_b16 a[230:231], v11 offset:33280
 v_mfma_f32_16x16x32_bf16 v[116:119], a[116:119], a[252:255], v[116:119]
 buffer_load_dwordx4 v4, s[40:43], s83 offen offset:1024 lds
 ds_read_b128 a[144:147], v18 offset:0
 ds_read_b128 a[148:151], v18 offset:2048
 v_mfma_f32_16x16x32_bf16 v[120:123], a[120:123], a[252:255], v[120:123]
 ds_read_b128 a[152:155], v18 offset:4096
 ds_read_b128 a[156:159], v18 offset:6144
 s_add_u32 m0, s81, 114688
 v_mfma_f32_16x16x32_bf16 v[124:127], a[124:127], a[252:255], v[124:127]
 s_add_u32 s83, s83, 114688
 s_waitcnt lgkmcnt(6)
 v_mfma_f32_16x16x32_bf16 v[96:99], a[128:131], a[224:227], v[96:99]
 buffer_load_dwordx4 v4, s[36:39], s83 offen offset:0 lds
 ds_read_b64_tr_b16 a[232:233], v10 offset:36864
 ds_read_b64_tr_b16 a[234:235], v10 offset:37376
 v_mfma_f32_16x16x32_bf16 v[100:103], a[132:135], a[224:227], v[100:103]
 v_mfma_f32_16x16x32_bf16 v[104:107], a[136:139], a[224:227], v[104:107]
 buffer_load_dwordx4 v4, s[40:43], s83 offen offset:1024 lds
 v_mfma_f32_16x16x32_bf16 v[108:111], a[140:143], a[224:227], v[108:111]
 s_waitcnt lgkmcnt(6)
 v_mfma_f32_16x16x32_bf16 v[112:115], a[128:131], a[228:231], v[112:115]
 ds_read_b64_tr_b16 a[236:237], v11 offset:36864
 ds_read_b64_tr_b16 a[238:239], v11 offset:37376
 v_mfma_f32_16x16x32_bf16 v[116:119], a[132:135], a[228:231], v[116:119]
 v_mfma_f32_16x16x32_bf16 v[120:123], a[136:139], a[228:231], v[120:123]
 v_mfma_f32_16x16x32_bf16 v[124:127], a[140:143], a[228:231], v[124:127]
 s_waitcnt lgkmcnt(2)
 v_mfma_f32_16x16x32_bf16 v[96:99], a[144:147], a[232:235], v[96:99]
 s_waitcnt vmcnt(10)
 s_barrier
 ds_read_b128 a[160:163], v17 offset:16384
 ds_read_b128 a[164:167], v17 offset:18432
 v_mfma_f32_16x16x32_bf16 v[100:103], a[148:151], a[232:235], v[100:103]
 ds_read_b128 a[168:171], v17 offset:20480
 ds_read_b128 a[172:175], v17 offset:22528
 s_add_u32 m0, s81, 122880
 v_mfma_f32_16x16x32_bf16 v[104:107], a[152:155], a[232:235], v[104:107]
 ds_read_b64_tr_b16 a[240:241], v10 offset:0
 ds_read_b64_tr_b16 a[242:243], v10 offset:512
 s_add_u32 s83, s83, 114688
 v_mfma_f32_16x16x32_bf16 v[108:111], a[156:159], a[232:235], v[108:111]
 s_cmp_eq_u32 s83, 1605632
 s_cselect_b32 s83, 0, s83
 s_waitcnt lgkmcnt(6)
 v_mfma_f32_16x16x32_bf16 v[112:115], a[144:147], a[236:239], v[112:115]
 buffer_load_dwordx4 v4, s[36:39], s83 offen offset:0 lds
 ds_read_b64_tr_b16 a[244:245], v11 offset:0
 ds_read_b64_tr_b16 a[246:247], v11 offset:512
 v_mfma_f32_16x16x32_bf16 v[116:119], a[148:151], a[236:239], v[116:119]
 ds_read_b128 a[176:179], v18 offset:16384
 ds_read_b128 a[180:183], v18 offset:18432
 v_mfma_f32_16x16x32_bf16 v[120:123], a[152:155], a[236:239], v[120:123]
 buffer_load_dwordx4 v4, s[40:43], s83 offen offset:1024 lds
 ds_read_b128 a[184:187], v18 offset:20480
 ds_read_b128 a[188:191], v18 offset:22528
 v_mfma_f32_16x16x32_bf16 v[124:127], a[156:159], a[236:239], v[124:127]
 s_add_u32 m0, s81, 131072
 s_add_u32 s83, s83, 114688
 s_waitcnt lgkmcnt(6)
 v_mfma_f32_16x16x32_bf16 v[96:99], a[160:163], a[240:243], v[96:99]
 buffer_load_dwordx4 v4, s[36:39], s83 offen offset:0 lds
 ds_read_b64_tr_b16 a[248:249], v10 offset:4096
 ds_read_b64_tr_b16 a[250:251], v10 offset:4608
 v_mfma_f32_16x16x32_bf16 v[100:103], a[164:167], a[240:243], v[100:103]
 v_mfma_f32_16x16x32_bf16 v[104:107], a[168:171], a[240:243], v[104:107]
 buffer_load_dwordx4 v4, s[40:43], s83 offen offset:1024 lds
 v_mfma_f32_16x16x32_bf16 v[108:111], a[172:175], a[240:243], v[108:111]
 s_waitcnt lgkmcnt(6)
 v_mfma_f32_16x16x32_bf16 v[112:115], a[160:163], a[244:247], v[112:115]
 ds_read_b64_tr_b16 a[252:253], v11 offset:4096
 ds_read_b64_tr_b16 a[254:255], v11 offset:4608
 v_mfma_f32_16x16x32_bf16 v[116:119], a[164:167], a[244:247], v[116:119]
 v_mfma_f32_16x16x32_bf16 v[120:123], a[168:171], a[244:247], v[120:123]
 v_mfma_f32_16x16x32_bf16 v[124:127], a[172:175], a[244:247], v[124:127]
 s_waitcnt lgkmcnt(2)
 v_mfma_f32_16x16x32_bf16 v[96:99], a[176:179], a[248:251], v[96:99]
 s_waitcnt vmcnt(8)
 s_barrier
 v_min_u32 v59, 60, v3
 buffer_load_dword v13, v59, s[48:51], 0 offen sc1
 ds_read_b128 a[192:195], v17 offset:32768
 ds_read_b128 a[196:199], v17 offset:34816
 v_mfma_f32_16x16x32_bf16 v[100:103], a[180:183], a[248:251], v[100:103]
 ds_read_b128 a[200:203], v17 offset:36864
 ds_read_b128 a[204:207], v17 offset:38912
 v_mfma_f32_16x16x32_bf16 v[104:107], a[184:187], a[248:251], v[104:107]
 ds_read_b64_tr_b16 a[224:225], v10 offset:8192
 ds_read_b64_tr_b16 a[226:227], v10 offset:8704
 s_add_u32 m0, s81, 139264
 v_mfma_f32_16x16x32_bf16 v[108:111], a[188:191], a[248:251], v[108:111]
 s_add_u32 s83, s83, 114688
 s_cmp_eq_u32 s83, 1605632
 s_cselect_b32 s83, 0, s83
 s_waitcnt lgkmcnt(6)
 v_mfma_f32_16x16x32_bf16 v[112:115], a[176:179], a[252:255], v[112:115]
 buffer_load_dwordx4 v4, s[36:39], s83 offen offset:0 lds
 ds_read_b64_tr_b16 a[228:229], v11 offset:8192
 ds_read_b64_tr_b16 a[230:231], v11 offset:8704
 v_mfma_f32_16x16x32_bf16 v[116:119], a[180:183], a[252:255], v[116:119]
 ds_read_b128 a[208:211], v18 offset:32768
 ds_read_b128 a[212:215], v18 offset:34816
 v_mfma_f32_16x16x32_bf16 v[120:123], a[184:187], a[252:255], v[120:123]
 ds_read_b128 a[216:219], v18 offset:36864
 ds_read_b128 a[220:223], v18 offset:38912
 v_mfma_f32_16x16x32_bf16 v[124:127], a[188:191], a[252:255], v[124:127]
 s_waitcnt lgkmcnt(6)
 v_mfma_f32_16x16x32_bf16 v[96:99], a[192:195], a[224:227], v[96:99]
 buffer_load_dwordx4 v4, s[40:43], s83 offen offset:1024 lds
 ds_read_b64_tr_b16 a[232:233], v10 offset:12288
 ds_read_b64_tr_b16 a[234:235], v10 offset:12800
 v_mfma_f32_16x16x32_bf16 v[100:103], a[196:199], a[224:227], v[100:103]
 v_mfma_f32_16x16x32_bf16 v[104:107], a[200:203], a[224:227], v[104:107]
 s_add_u32 m0, s81, 147456
 s_add_u32 s83, s83, 114688
 v_mfma_f32_16x16x32_bf16 v[108:111], a[204:207], a[224:227], v[108:111]
 s_waitcnt lgkmcnt(6)
 v_mfma_f32_16x16x32_bf16 v[112:115], a[192:195], a[228:231], v[112:115]
 buffer_load_dwordx4 v4, s[36:39], s83 offen offset:0 lds
 ds_read_b64_tr_b16 a[236:237], v11 offset:12288
 ds_read_b64_tr_b16 a[238:239], v11 offset:12800
 v_mfma_f32_16x16x32_bf16 v[116:119], a[196:199], a[228:231], v[116:119]
 v_mfma_f32_16x16x32_bf16 v[120:123], a[200:203], a[228:231], v[120:123]
 v_mfma_f32_16x16x32_bf16 v[124:127], a[204:207], a[228:231], v[124:127]
 s_waitcnt lgkmcnt(2)
 v_mfma_f32_16x16x32_bf16 v[96:99], a[208:211], a[232:235], v[96:99]
 buffer_load_dwordx4 v4, s[40:43], s83 offen offset:1024 lds
 v_mfma_f32_16x16x32_bf16 v[100:103], a[212:215], a[232:235], v[100:103]
 v_mfma_f32_16x16x32_bf16 v[104:107], a[216:219], a[232:235], v[104:107]
 v_mfma_f32_16x16x32_bf16 v[108:111], a[220:223], a[232:235], v[108:111]
 s_waitcnt lgkmcnt(0)
 v_mfma_f32_16x16x32_bf16 v[112:115], a[208:211], a[236:239], v[112:115]
 v_mfma_f32_16x16x32_bf16 v[116:119], a[212:215], a[236:239], v[116:119]
 v_mfma_f32_16x16x32_bf16 v[120:123], a[216:219], a[236:239], v[120:123]
 v_mfma_f32_16x16x32_bf16 v[124:127], a[220:223], a[236:239], v[124:127]
 v_fmamk_f32 v36, v96, 0x3fb8aa3b, v91
 v_fmamk_f32 v37, v97, 0x3fb8aa3b, v91
 v_fmamk_f32 v38, v98, 0x3fb8aa3b, v91
 v_fmamk_f32 v39, v99, 0x3fb8aa3b, v91
 v_exp_f32_e64 v36, v36 clamp
 v_max_f32 v96, s91, v96
 v_exp_f32_e64 v37, v37 clamp
 v_max_f32 v97, s91, v97
 v_exp_f32_e64 v38, v38 clamp
 v_max_f32 v98, s91, v98
 v_exp_f32_e64 v39, v39 clamp
 v_max_f32 v99, s91, v99
 v_fmac_f32 v96, s98, v36
 v_fmac_f32 v97, s98, v37
 v_fmac_f32 v98, s98, v38
 v_fmac_f32 v99, s98, v39
 v_fmamk_f32 v36, v100, 0x3fb8aa3b, v91
 v_fmamk_f32 v37, v101, 0x3fb8aa3b, v91
 v_fmamk_f32 v38, v102, 0x3fb8aa3b, v91
 v_fmamk_f32 v39, v103, 0x3fb8aa3b, v91
 v_exp_f32_e64 v36, v36 clamp
 v_max_f32 v100, s91, v100
 v_exp_f32_e64 v37, v37 clamp
 v_max_f32 v101, s91, v101
 v_exp_f32_e64 v38, v38 clamp
 v_max_f32 v102, s91, v102
 v_exp_f32_e64 v39, v39 clamp
 v_max_f32 v103, s91, v103
 v_fmac_f32 v100, s98, v36
 v_fmac_f32 v101, s98, v37
 v_fmac_f32 v102, s98, v38
 v_fmac_f32 v103, s98, v39
 v_cvt_pk_bf16_f32 v40, v96, v97
 v_cvt_pk_bf16_f32 v41, v98, v99
 v_cvt_pk_bf16_f32 v42, v100, v101
 v_cvt_pk_bf16_f32 v43, v102, v103
 buffer_store_dwordx4 v[40:43], v9, s[44:47], 0 offen offset:0 sc1
 v_fmamk_f32 v36, v104, 0x3fb8aa3b, v91
 v_fmamk_f32 v37, v105, 0x3fb8aa3b, v91
 v_fmamk_f32 v38, v106, 0x3fb8aa3b, v91
 v_fmamk_f32 v39, v107, 0x3fb8aa3b, v91
 v_exp_f32_e64 v36, v36 clamp
 v_max_f32 v104, s91, v104
 v_exp_f32_e64 v37, v37 clamp
 v_max_f32 v105, s91, v105
 v_exp_f32_e64 v38, v38 clamp
 v_max_f32 v106, s91, v106
 v_exp_f32_e64 v39, v39 clamp
 v_max_f32 v107, s91, v107
 v_fmac_f32 v104, s98, v36
 v_fmac_f32 v105, s98, v37
 v_fmac_f32 v106, s98, v38
 v_fmac_f32 v107, s98, v39
 v_fmamk_f32 v36, v108, 0x3fb8aa3b, v91
 v_fmamk_f32 v37, v109, 0x3fb8aa3b, v91
 v_fmamk_f32 v38, v110, 0x3fb8aa3b, v91
 v_fmamk_f32 v39, v111, 0x3fb8aa3b, v91
 v_exp_f32_e64 v36, v36 clamp
 v_max_f32 v108, s91, v108
 v_exp_f32_e64 v37, v37 clamp
 v_max_f32 v109, s91, v109
 v_exp_f32_e64 v38, v38 clamp
 v_max_f32 v110, s91, v110
 v_exp_f32_e64 v39, v39 clamp
 v_max_f32 v111, s91, v111
 v_fmac_f32 v108, s98, v36
 v_fmac_f32 v109, s98, v37
 v_fmac_f32 v110, s98, v38
 v_fmac_f32 v111, s98, v39
 v_cvt_pk_bf16_f32 v44, v104, v105
 v_cvt_pk_bf16_f32 v45, v106, v107
 v_cvt_pk_bf16_f32 v46, v108, v109
 v_cvt_pk_bf16_f32 v47, v110, v111
 buffer_store_dwordx4 v[44:47], v9, s[44:47], 0 offen offset:512 sc1
 v_fmamk_f32 v36, v112, 0x3fb8aa3b, v91
 v_fmamk_f32 v37, v113, 0x3fb8aa3b, v91
 v_fmamk_f32 v38, v114, 0x3fb8aa3b, v91
 v_fmamk_f32 v39, v115, 0x3fb8aa3b, v91
 v_exp_f32_e64 v36, v36 clamp
 v_max_f32 v112, s91, v112
 v_exp_f32_e64 v37, v37 clamp
 v_max_f32 v113, s91, v113
 v_exp_f32_e64 v38, v38 clamp
 v_max_f32 v114, s91, v114
 v_exp_f32_e64 v39, v39 clamp
 v_max_f32 v115, s91, v115
 v_fmac_f32 v112, s98, v36
 v_fmac_f32 v113, s98, v37
 v_fmac_f32 v114, s98, v38
 v_fmac_f32 v115, s98, v39
 v_fmamk_f32 v36, v116, 0x3fb8aa3b, v91
 v_fmamk_f32 v37, v117, 0x3fb8aa3b, v91
 v_fmamk_f32 v38, v118, 0x3fb8aa3b, v91
 v_fmamk_f32 v39, v119, 0x3fb8aa3b, v91
 v_exp_f32_e64 v36, v36 clamp
 v_max_f32 v116, s91, v116
 v_exp_f32_e64 v37, v37 clamp
 v_max_f32 v117, s91, v117
 v_exp_f32_e64 v38, v38 clamp
 v_max_f32 v118, s91, v118
 v_exp_f32_e64 v39, v39 clamp
 v_max_f32 v119, s91, v119
 v_fmac_f32 v116, s98, v36
 v_fmac_f32 v117, s98, v37
 v_fmac_f32 v118, s98, v38
 v_fmac_f32 v119, s98, v39
 v_cvt_pk_bf16_f32 v40, v112, v113
 v_cvt_pk_bf16_f32 v41, v114, v115
 v_cvt_pk_bf16_f32 v42, v116, v117
 v_cvt_pk_bf16_f32 v43, v118, v119
 s_mov_b32 s88, 66560
 buffer_store_dwordx4 v[40:43], v9, s[44:47], s88 offen offset:0 sc1
 v_fmamk_f32 v36, v120, 0x3fb8aa3b, v91
 v_fmamk_f32 v37, v121, 0x3fb8aa3b, v91
 v_fmamk_f32 v38, v122, 0x3fb8aa3b, v91
 v_fmamk_f32 v39, v123, 0x3fb8aa3b, v91
 v_exp_f32_e64 v36, v36 clamp
 v_max_f32 v120, s91, v120
 v_exp_f32_e64 v37, v37 clamp
 v_max_f32 v121, s91, v121
 v_exp_f32_e64 v38, v38 clamp
 v_max_f32 v122, s91, v122
 v_exp_f32_e64 v39, v39 clamp
 v_max_f32 v123, s91, v123
 v_fmac_f32 v120, s98, v36
 v_fmac_f32 v121, s98, v37
 v_fmac_f32 v122, s98, v38
 v_fmac_f32 v123, s98, v39
 v_fmamk_f32 v36, v124, 0x3fb8aa3b, v91
 v_fmamk_f32 v37, v125, 0x3fb8aa3b, v91
 v_fmamk_f32 v38, v126, 0x3fb8aa3b, v91
 s_waitcnt vmcnt(12)
 s_barrier
 ds_read_b64_tr_b16 a[240:241], v25 offset:40960
 ds_read_b64_tr_b16 a[242:243], v25 offset:41472
 ds_read_b64_tr_b16 a[244:245], v26 offset:40960
 ds_read_b64_tr_b16 a[246:247], v26 offset:41472
 ds_read_b64_tr_b16 a[248:249], v25 offset:41984
 ds_read_b64_tr_b16 a[250:251], v25 offset:42496
 v_fmamk_f32 v39, v127, 0x3fb8aa3b, v91
 v_exp_f32_e64 v36, v36 clamp
 v_max_f32 v124, s91, v124
 v_exp_f32_e64 v37, v37 clamp
 v_max_f32 v125, s91, v125
 v_exp_f32_e64 v38, v38 clamp
 v_max_f32 v126, s91, v126
 v_exp_f32_e64 v39, v39 clamp
 v_max_f32 v127, s91, v127
 v_fmac_f32 v124, s98, v36
 v_fmac_f32 v125, s98, v37
 v_fmac_f32 v126, s98, v38
 v_fmac_f32 v127, s98, v39
 v_cvt_pk_bf16_f32 v44, v120, v121
 v_cvt_pk_bf16_f32 v45, v122, v123
 v_cvt_pk_bf16_f32 v46, v124, v125
 s_waitcnt lgkmcnt(2)
 v_mfma_f32_16x16x32_bf16 v[128:131], a[240:243], a[0:3], 0
 ds_read_b64_tr_b16 a[252:253], v26 offset:41984
 s_add_u32 m0, s81, 155648
 v_mfma_f32_16x16x32_bf16 v[144:147], a[240:243], a[4:7], 0
 ds_read_b64_tr_b16 a[254:255], v26 offset:42496
 s_mov_b32 s10, 0
 v_mfma_f32_16x16x32_bf16 v[160:163], a[240:243], a[8:11], 0
 buffer_load_dwordx4 v60, s[52:55], s10 offen offset:0 lds
 v_cvt_pk_bf16_f32 v47, v126, v127
 v_mfma_f32_16x16x32_bf16 v[176:179], a[240:243], a[12:15], 0
 v_mfma_f32_16x16x32_bf16 v[132:135], a[244:247], a[0:3], 0
 buffer_store_dwordx4 v[44:47], v9, s[44:47], s88 offen offset:512 sc1
 ds_read_b64_tr_b16 a[224:225], v25 offset:49152
 v_mfma_f32_16x16x32_bf16 v[148:151], a[244:247], a[4:7], 0
 ds_read_b64_tr_b16 a[226:227], v25 offset:49664
 v_mfma_f32_16x16x32_bf16 v[164:167], a[244:247], a[8:11], 0
 v_mfma_f32_16x16x32_bf16 v[180:183], a[244:247], a[12:15], 0
 s_waitcnt lgkmcnt(2)
 v_mfma_f32_16x16x32_bf16 v[136:139], a[248:251], a[0:3], 0
 buffer_load_dwordx4 v61, s[52:55], s10 offen offset:1024 lds
 ds_read_b64_tr_b16 a[228:229], v26 offset:49152
 v_mfma_f32_16x16x32_bf16 v[152:155], a[248:251], a[4:7], 0
 ds_read_b64_tr_b16 a[230:231], v26 offset:49664
 v_mfma_f32_16x16x32_bf16 v[168:171], a[248:251], a[8:11], 0
 v_mfma_f32_16x16x32_bf16 v[184:187], a[248:251], a[12:15], 0
 s_add_u32 m0, s81, 49152
 s_mov_b32 s10, 7168
 v_mfma_f32_16x16x32_bf16 v[140:143], a[252:255], a[0:3], 0
 buffer_load_dwordx4 v60, s[52:55], s10 offen offset:0 lds
 ds_read_b64_tr_b16 a[232:233], v25 offset:50176
 v_mfma_f32_16x16x32_bf16 v[156:159], a[252:255], a[4:7], 0
 ds_read_b64_tr_b16 a[234:235], v25 offset:50688
 v_mfma_f32_16x16x32_bf16 v[172:175], a[252:255], a[8:11], 0
 v_mfma_f32_16x16x32_bf16 v[188:191], a[252:255], a[12:15], 0
 s_waitcnt lgkmcnt(2)
 v_mfma_f32_16x16x32_bf16 v[128:131], a[224:227], a[16:19], v[128:131]
 buffer_load_dwordx4 v61, s[52:55], s10 offen offset:1024 lds
 ds_read_b64_tr_b16 a[236:237], v26 offset:50176
 v_mfma_f32_16x16x32_bf16 v[144:147], a[224:227], a[20:23], v[144:147]
 ds_read_b64_tr_b16 a[238:239], v26 offset:50688
 v_mfma_f32_16x16x32_bf16 v[160:163], a[224:227], a[24:27], v[160:163]
 v_mfma_f32_16x16x32_bf16 v[176:179], a[224:227], a[28:31], v[176:179]
 s_add_u32 m0, s81, 57344
 s_mov_b32 s10, 229376
 v_mfma_f32_16x16x32_bf16 v[132:135], a[228:231], a[16:19], v[132:135]
 buffer_load_dwordx4 v60, s[52:55], s10 offen offset:0 lds
 s_waitcnt vmcnt(14)
 s_barrier
 s_waitcnt vmcnt(13)
 v_cmp_lt_u32 vcc, 0, v13
 s_nop 0
 s_cmp_eq_u64 vcc, -1
 s_cbranch_scc0 L_spin_z2
L_ok_z2:
 ds_read_b64_tr_b16 a[240:241], v25 offset:57344
 v_mfma_f32_16x16x32_bf16 v[148:151], a[228:231], a[20:23], v[148:151]
 buffer_load_dwordx4 v61, s[52:55], s10 offen offset:1024 lds
 ds_read_b64_tr_b16 a[242:243], v25 offset:57856
 v_mfma_f32_16x16x32_bf16 v[164:167], a[228:231], a[24:27], v[164:167]
 v_mfma_f32_16x16x32_bf16 v[180:183], a[228:231], a[28:31], v[180:183]
 s_waitcnt lgkmcnt(2)
 v_mfma_f32_16x16x32_bf16 v[136:139], a[232:235], a[16:19], v[136:139]
 ds_read_b64_tr_b16 a[244:245], v26 offset:57344
 s_add_u32 m0, s81, 81920
 s_add_u32 s83, s83, 114688
 v_mfma_f32_16x16x32_bf16 v[152:155], a[232:235], a[20:23], v[152:155]
 ds_read_b64_tr_b16 a[246:247], v26 offset:57856
 s_cmp_eq_u32 s83, 1605632
 s_cselect_b32 s83, 0, s83
 v_mfma_f32_16x16x32_bf16 v[168:171], a[232:235], a[24:27], v[168:171]
 buffer_load_dwordx4 v4, s[36:39], s83 offen offset:0 lds
 v_mfma_f32_16x16x32_bf16 v[184:187], a[232:235], a[28:31], v[184:187]
 v_mfma_f32_16x16x32_bf16 v[140:143], a[236:239], a[16:19], v[140:143]
 ds_read_b64_tr_b16 a[248:249], v25 offset:58368
 v_mfma_f32_16x16x32_bf16 v[156:159], a[236:239], a[20:23], v[156:159]
 ds_read_b64_tr_b16 a[250:251], v25 offset:58880
 v_mfma_f32_16x16x32_bf16 v[172:175], a[236:239], a[24:27], v[172:175]
 buffer_load_dwordx4 v4, s[40:43], s83 offen offset:1024 lds
 v_mfma_f32_16x16x32_bf16 v[188:191], a[236:239], a[28:31], v[188:191]
 s_waitcnt lgkmcnt(2)
 v_mfma_f32_16x16x32_bf16 v[128:131], a[240:243], a[32:35], v[128:131]
 ds_read_b64_tr_b16 a[252:253], v26 offset:58368
 v_mfma_f32_16x16x32_bf16 v[144:147], a[240:243], a[36:39], v[144:147]
 ds_read_b64_tr_b16 a[254:255], v26 offset:58880
 s_add_u32 m0, s81, 0
 s_add_u32 s83, s83, 114688
 v_mfma_f32_16x16x32_bf16 v[160:163], a[240:243], a[40:43], v[160:163]
 buffer_load_dwordx4 v4, s[36:39], s83 offen offset:0 lds
 v_mfma_f32_16x16x32_bf16 v[176:179], a[240:243], a[44:47], v[176:179]
 s_waitcnt vmcnt(8)
 s_barrier
 s_cmp_eq_u32 s72, 0
 s_cbranch_scc0 L_sigP
 buffer_store_dword v15, v33, s[44:47], s27 offen sc1
L_sigP:
 v_mov_b32 v13, 2
 v_mfma_f32_16x16x32_bf16 v[132:135], a[244:247], a[32:35], v[132:135]
 ds_read_b64_tr_b16 a[224:225], v29 offset:0
 v_mfma_f32_16x16x32_bf16 v[148:151], a[244:247], a[36:39], v[148:151]
 ds_read_b64_tr_b16 a[226:227], v29 offset:512
 v_mfma_f32_16x16x32_bf16 v[164:167], a[244:247], a[40:43], v[164:167]
 v_mfma_f32_16x16x32_bf16 v[180:183], a[244:247], a[44:47], v[180:183]
 buffer_load_dwordx4 v4, s[40:43], s83 offen offset:1024 lds
 s_waitcnt lgkmcnt(2)
 v_mfma_f32_16x16x32_bf16 v[136:139], a[248:251], a[32:35], v[136:139]
 ds_read_b64_tr_b16 a[228:229], v30 offset:0
 v_mfma_f32_16x16x32_bf16 v[152:155], a[248:251], a[36:39], v[152:155]
 ds_read_b64_tr_b16 a[230:231], v30 offset:512
 v_mfma_f32_16x16x32_bf16 v[168:171], a[248:251], a[40:43], v[168:171]
 s_add_u32 m0, s81, 8192
 s_mov_b32 s10, 236544
 v_mfma_f32_16x16x32_bf16 v[184:187], a[248:251], a[44:47], v[184:187]
 buffer_load_dwordx4 v60, s[52:55], s10 offen offset:0 lds
 v_mfma_f32_16x16x32_bf16 v[140:143], a[252:255], a[32:35], v[140:143]
 ds_read_b64_tr_b16 a[232:233], v29 offset:1024
 v_mfma_f32_16x16x32_bf16 v[156:159], a[252:255], a[36:39], v[156:159]
 ds_read_b64_tr_b16 a[234:235], v29 offset:1536
 v_mfma_f32_16x16x32_bf16 v[172:175], a[252:255], a[40:43], v[172:175]
 v_mfma_f32_16x16x32_bf16 v[188:191], a[252:255], a[44:47], v[188:191]
 buffer_load_dwordx4 v61, s[52:55], s10 offen offset:1024 lds
 s_waitcnt lgkmcnt(2)
 v_mfma_f32_16x16x32_bf16 v[128:131], a[224:227], a[48:51], v[128:131]
 ds_read_b64_tr_b16 a[236:237], v30 offset:1024
 v_mfma_f32_16x16x32_bf16 v[144:147], a[224:227], a[52:55], v[144:147]
 ds_read_b64_tr_b16 a[238:239], v30 offset:1536
 v_mfma_f32_16x16x32_bf16 v[160:163], a[224:227], a[56:59], v[160:163]
 s_waitcnt vmcnt(10)
 ds_read_b64_tr_b16 v[96:97], v73 offset:24576
 ds_read_b64_tr_b16 v[98:99], v73 offset:25600
 v_mfma_f32_16x16x32_bf16 v[176:179], a[224:227], a[60:63], v[176:179]
 ds_read_b64_tr_b16 v[100:101], v74 offset:24576
 ds_read_b64_tr_b16 v[102:103], v74 offset:25600
 s_add_u32 m0, s81, 90112
 v_mfma_f32_16x16x32_bf16 v[132:135], a[228:231], a[48:51], v[132:135]
 s_mov_b32 s10, 458752
 buffer_load_dwordx4 v60, s[52:55], s10 offen offset:0 lds
 s_barrier
 ds_read_b64_tr_b16 a[240:241], v29 offset:8192
 v_mfma_f32_16x16x32_bf16 v[148:151], a[228:231], a[52:55], v[148:151]
 ds_read_b64_tr_b16 a[242:243], v29 offset:8704
 v_mfma_f32_16x16x32_bf16 v[164:167], a[228:231], a[56:59], v[164:167]
 v_mfma_f32_16x16x32_bf16 v[180:183], a[228:231], a[60:63], v[180:183]
 buffer_load_dwordx4 v61, s[52:55], s10 offen offset:1024 lds
 s_waitcnt lgkmcnt(6)
 v_mfma_f32_16x16x32_bf16 v[136:139], a[232:235], a[48:51], v[136:139]
 ds_read_b64_tr_b16 a[244:245], v30 offset:8192
 v_mfma_f32_16x16x32_bf16 v[152:155], a[232:235], a[52:55], v[152:155]
 ds_read_b64_tr_b16 a[246:247], v30 offset:8704
 v_mfma_f32_16x16x32_bf16 v[168:171], a[232:235], a[56:59], v[168:171]
 s_waitcnt vmcnt(10)
 ds_read_b64_tr_b16 v[104:105], v69 offset:49152
 ds_read_b64_tr_b16 v[106:107], v69 offset:50176
 v_mfma_f32_16x16x32_bf16 v[184:187], a[232:235], a[60:63], v[184:187]
 ds_read_b64_tr_b16 v[108:109], v70 offset:49152
 ds_read_b64_tr_b16 v[110:111], v70 offset:50176
 s_add_u32 m0, s81, 16384
 v_mfma_f32_16x16x32_bf16 v[140:143], a[236:239], a[48:51], v[140:143]
 ds_read_b64_tr_b16 a[248:249], v29 offset:9216
 s_add_u32 s83, s83, 114688
 s_cmp_eq_u32 s83, 1605632
 s_cselect_b32 s83, 0, s83
 v_mfma_f32_16x16x32_bf16 v[156:159], a[236:239], a[52:55], v[156:159]
 buffer_load_dwordx4 v4, s[36:39], s83 offen offset:0 lds
 ds_read_b64_tr_b16 a[250:251], v29 offset:9728
 v_mfma_f32_16x16x32_bf16 v[172:175], a[236:239], a[56:59], v[172:175]
 v_mfma_f32_16x16x32_bf16 v[188:191], a[236:239], a[60:63], v[188:191]
 s_waitcnt lgkmcnt(6)
 v_mfma_f32_16x16x32_bf16 v[128:131], a[240:243], a[64:67], v[128:131]
 ds_read_b64_tr_b16 a[252:253], v30 offset:9216
 v_mfma_f32_16x16x32_bf16 v[144:147], a[240:243], a[68:71], v[144:147]
 buffer_load_dwordx4 v4, s[40:43], s83 offen offset:1024 lds
 ds_read_b64_tr_b16 a[254:255], v30 offset:9728
 v_mfma_f32_16x16x32_bf16 v[160:163], a[240:243], a[72:75], v[160:163]
 s_waitcnt vmcnt(10)
 ds_read_b64_tr_b16 v[112:113], v69 offset:57344
 ds_read_b64_tr_b16 v[114:115], v69 offset:58368
 v_mfma_f32_16x16x32_bf16 v[176:179], a[240:243], a[76:79], v[176:179]
 ds_read_b64_tr_b16 v[116:117], v70 offset:57344
 ds_read_b64_tr_b16 v[118:119], v70 offset:58368
 s_add_u32 m0, s81, 24576
 v_mfma_f32_16x16x32_bf16 v[132:135], a[244:247], a[64:67], v[132:135]
 ds_read_b64_tr_b16 a[224:225], v29 offset:16384
 s_add_u32 s83, s83, 114688
 v_mfma_f32_16x16x32_bf16 v[148:151], a[244:247], a[68:71], v[148:151]
 buffer_load_dwordx4 v4, s[36:39], s83 offen offset:0 lds
 ds_read_b64_tr_b16 a[226:227], v29 offset:16896
 v_mfma_f32_16x16x32_bf16 v[164:167], a[244:247], a[72:75], v[164:167]
 v_mfma_f32_16x16x32_bf16 v[180:183], a[244:247], a[76:79], v[180:183]
 s_waitcnt lgkmcnt(6)
 v_mfma_f32_16x16x32_bf16 v[136:139], a[248:251], a[64:67], v[136:139]
 ds_read_b64_tr_b16 a[228:229], v30 offset:16384
 v_mfma_f32_16x16x32_bf16 v[152:155], a[248:251], a[68:71], v[152:155]
 buffer_load_dwordx4 v4, s[40:43], s83 offen offset:1024 lds
 ds_read_b64_tr_b16 a[230:231], v30 offset:16896
 v_mfma_f32_16x16x32_bf16 v[168:171], a[248:251], a[72:75], v[168:171]
 v_mfma_f32_16x16x32_bf16 v[184:187], a[248:251], a[76:79], v[184:187]
 v_mfma_f32_16x16x32_bf16 v[140:143], a[252:255], a[64:67], v[140:143]
 ds_read_b64_tr_b16 a[232:233], v29 offset:17408
 s_add_u32 m0, s81, 155648
 s_mov_b32 s10, 465920
 v_mfma_f32_16x16x32_bf16 v[156:159], a[252:255], a[68:71], v[156:159]
 buffer_load_dwordx4 v60, s[52:55], s10 offen offset:0 lds
 ds_read_b64_tr_b16 a[234:235], v29 offset:17920
 v_mfma_f32_16x16x32_bf16 v[172:175], a[252:255], a[72:75], v[172:175]
 v_mfma_f32_16x16x32_bf16 v[188:191], a[252:255], a[76:79], v[188:191]
 s_waitcnt lgkmcnt(2)
 v_mfma_f32_16x16x32_bf16 v[128:131], a[224:227], a[80:83], v[128:131]
 ds_read_b64_tr_b16 a[236:237], v30 offset:17408
 v_mfma_f32_16x16x32_bf16 v[144:147], a[224:227], a[84:87], v[144:147]
 buffer_load_dwordx4 v61, s[52:55], s10 offen offset:1024 lds
 ds_read_b64_tr_b16 a[238:239], v30 offset:17920
 v_mfma_f32_16x16x32_bf16 v[160:163], a[224:227], a[88:91], v[160:163]
 v_mfma_f32_16x16x32_bf16 v[176:179], a[224:227], a[92:95], v[176:179]
 v_mfma_f32_16x16x32_bf16 v[132:135], a[228:231], a[80:83], v[132:135]
 s_add_u32 m0, s81, 49152
 s_mov_b32 s10, 688128
 buffer_load_dwordx4 v60, s[52:55], s10 offen offset:0 lds
 s_waitcnt vmcnt(11)
 s_barrier
 s_bitcmp1_b32 4, s78
 s_cbranch_scc0 L_tch10
 buffer_load_dword v16, v16, s[68:71], 0 offen
L_tch10:
 ds_read_b64_tr_b16 a[240:241], v25 offset:16384
 v_mfma_f32_16x16x32_bf16 v[148:151], a[228:231], a[84:87], v[148:151]
 ds_read_b64_tr_b16 a[242:243], v25 offset:16896
 v_mfma_f32_16x16x32_bf16 v[164:167], a[228:231], a[88:91], v[164:167]
 v_mfma_f32_16x16x32_bf16 v[180:183], a[228:231], a[92:95], v[180:183]
 s_waitcnt lgkmcnt(2)
 v_mfma_f32_16x16x32_bf16 v[136:139], a[232:235], a[80:83], v[136:139]
 buffer_load_dwordx4 v61, s[52:55], s10 offen offset:1024 lds
 ds_read_b64_tr_b16 a[244:245], v26 offset:16384
 v_mfma_f32_16x16x32_bf16 v[152:155], a[232:235], a[84:87], v[152:155]
 ds_read_b64_tr_b16 a[246:247], v26 offset:16896
 v_mfma_f32_16x16x32_bf16 v[168:171], a[232:235], a[88:91], v[168:171]
 s_waitcnt vmcnt(10)
 ds_read_b64_tr_b16 v[120:121], v69 offset:8192
 ds_read_b64_tr_b16 v[122:123], v69 offset:9216
 v_mfma_f32_16x16x32_bf16 v[184:187], a[232:235], a[92:95], v[184:187]
 ds_read_b64_tr_b16 v[124:125], v70 offset:8192
 ds_read_b64_tr_b16 v[126:127], v70 offset:9216
 s_add_u32 m0, s81, 98304
 v_mfma_f32_16x16x32_bf16 v[140:143], a[236:239], a[80:83], v[140:143]
 ds_read_b64_tr_b16 a[248:249], v25 offset:17408
 s_add_u32 s83, s83, 114688
 s_cmp_eq_u32 s83, 1605632
 s_cselect_b32 s83, 0, s83
 v_mfma_f32_16x16x32_bf16 v[156:159], a[236:239], a[84:87], v[156:159]
 buffer_load_dwordx4 v4, s[36:39], s83 offen offset:0 lds
 ds_read_b64_tr_b16 a[250:251], v25 offset:17920
 v_mfma_f32_16x16x32_bf16 v[172:175], a[236:239], a[88:91], v[172:175]
 v_mfma_f32_16x16x32_bf16 v[188:191], a[236:239], a[92:95], v[188:191]
 s_waitcnt lgkmcnt(6)
 v_mfma_f32_16x16x32_bf16 v[128:131], a[240:243], a[96:99], v[128:131]
 ds_read_b64_tr_b16 a[252:253], v26 offset:17408
 v_mfma_f32_16x16x32_bf16 v[144:147], a[240:243], a[100:103], v[144:147]
 buffer_load_dwordx4 v4, s[40:43], s83 offen offset:1024 lds
 ds_read_b64_tr_b16 a[254:255], v26 offset:17920
 v_mfma_f32_16x16x32_bf16 v[160:163], a[240:243], a[104:107], v[160:163]
 v_mfma_f32_16x16x32_bf16 v[176:179], a[240:243], a[108:111], v[176:179]
 v_mfma_f32_16x16x32_bf16 v[132:135], a[244:247], a[96:99], v[132:135]
 ds_read_b64_tr_b16 a[224:225], v21 offset:0
 s_add_u32 m0, s81, 32768
 s_add_u32 s83, s83, 114688
 v_mfma_f32_16x16x32_bf16 v[148:151], a[244:247], a[100:103], v[148:151]
 buffer_load_dwordx4 v4, s[36:39], s83 offen offset:0 lds
 ds_read_b64_tr_b16 a[226:227], v21 offset:512
 v_mfma_f32_16x16x32_bf16 v[164:167], a[244:247], a[104:107], v[164:167]
 v_mfma_f32_16x16x32_bf16 v[180:183], a[244:247], a[108:111], v[180:183]
 s_waitcnt lgkmcnt(2)
 v_mfma_f32_16x16x32_bf16 v[136:139], a[248:251], a[96:99], v[136:139]
 ds_read_b64_tr_b16 a[228:229], v22 offset:0
 v_mfma_f32_16x16x32_bf16 v[152:155], a[248:251], a[100:103], v[152:155]
 buffer_load_dwordx4 v4, s[40:43], s83 offen offset:1024 lds
 ds_read_b64_tr_b16 a[230:231], v22 offset:512
 v_mfma_f32_16x16x32_bf16 v[168:171], a[248:251], a[104:107], v[168:171]
 v_mfma_f32_16x16x32_bf16 v[184:187], a[248:251], a[108:111], v[184:187]
 v_mfma_f32_16x16x32_bf16 v[140:143], a[252:255], a[96:99], v[140:143]
 ds_read_b64_tr_b16 a[232:233], v21 offset:1024
 s_add_u32 m0, s81, 57344
 s_mov_b32 s10, 695296
 v_mfma_f32_16x16x32_bf16 v[156:159], a[252:255], a[100:103], v[156:159]
 buffer_load_dwordx4 v60, s[52:55], s10 offen offset:0 lds
 ds_read_b64_tr_b16 a[234:235], v21 offset:1536
 v_mfma_f32_16x16x32_bf16 v[172:175], a[252:255], a[104:107], v[172:175]
 v_mfma_f32_16x16x32_bf16 v[188:191], a[252:255], a[108:111], v[188:191]
 s_waitcnt lgkmcnt(2)
 v_mfma_f32_16x16x32_bf16 v[128:131], a[224:227], a[112:115], v[128:131]
 ds_read_b64_tr_b16 a[236:237], v22 offset:1024
 v_mfma_f32_16x16x32_bf16 v[144:147], a[224:227], a[116:119], v[144:147]
 buffer_load_dwordx4 v61, s[52:55], s10 offen offset:1024 lds
 ds_read_b64_tr_b16 a[238:239], v22 offset:1536
 v_mfma_f32_16x16x32_bf16 v[160:163], a[224:227], a[120:123], v[160:163]
 v_mfma_f32_16x16x32_bf16 v[176:179], a[224:227], a[124:127], v[176:179]
 v_mfma_f32_16x16x32_bf16 v[132:135], a[228:231], a[112:115], v[132:135]
 s_add_u32 m0, s81, 8192
 s_mov_b32 s10, 917504
 buffer_load_dwordx4 v60, s[52:55], s10 offen offset:0 lds
 s_waitcnt vmcnt(11)
 s_barrier
 ds_read_b64_tr_b16 a[240:241], v21 offset:16384
 v_mfma_f32_16x16x32_bf16 v[148:151], a[228:231], a[116:119], v[148:151]
 ds_read_b64_tr_b16 a[242:243], v21 offset:16896
 v_mfma_f32_16x16x32_bf16 v[164:167], a[228:231], a[120:123], v[164:167]
 buffer_load_dwordx4 v61, s[52:55], s10 offen offset:1024 lds
 v_mfma_f32_16x16x32_bf16 v[180:183], a[228:231], a[124:127], v[180:183]
 s_waitcnt lgkmcnt(2)
 v_mfma_f32_16x16x32_bf16 v[136:139], a[232:235], a[112:115], v[136:139]
 ds_read_b64_tr_b16 a[244:245], v22 offset:16384
 v_mfma_f32_16x16x32_bf16 v[152:155], a[232:235], a[116:119], v[152:155]
 ds_read_b64_tr_b16 a[246:247], v22 offset:16896
 s_add_u32 m0, s81, 40960
 s_add_u32 s83, s83, 114688
 v_mfma_f32_16x16x32_bf16 v[168:171], a[232:235], a[120:123], v[168:171]
 s_cmp_eq_u32 s83, 1605632
 s_cselect_b32 s83, 0, s83
 v_mfma_f32_16x16x32_bf16 v[184:187], a[232:235], a[124:127], v[184:187]
 buffer_load_dwordx4 v4, s[36:39], s83 offen offset:0 lds
 v_mfma_f32_16x16x32_bf16 v[140:143], a[236:239], a[112:115], v[140:143]
 ds_read_b64_tr_b16 a[248:249], v21 offset:17408
 v_mfma_f32_16x16x32_bf16 v[156:159], a[236:239], a[116:119], v[156:159]
 ds_read_b64_tr_b16 a[250:251], v21 offset:17920
 v_mfma_f32_16x16x32_bf16 v[172:175], a[236:239], a[120:123], v[172:175]
 v_mfma_f32_16x16x32_bf16 v[188:191], a[236:239], a[124:127], v[188:191]
 buffer_load_dwordx4 v4, s[40:43], s83 offen offset:1024 lds
 s_waitcnt lgkmcnt(2)
 v_mfma_f32_16x16x32_bf16 v[128:131], a[240:243], a[128:131], v[128:131]
 ds_read_b64_tr_b16 a[252:253], v22 offset:17408
 v_mfma_f32_16x16x32_bf16 v[144:147], a[240:243], a[132:135], v[144:147]
 ds_read_b64_tr_b16 a[254:255], v22 offset:17920
 v_mfma_f32_16x16x32_bf16 v[160:163], a[240:243], a[136:139], v[160:163]
 s_add_u32 m0, s81, 65536
 s_add_u32 s83, s83, 114688
 v_mfma_f32_16x16x32_bf16 v[176:179], a[240:243], a[140:143], v[176:179]
 buffer_load_dwordx4 v4, s[36:39], s83 offen offset:0 lds
 v_mfma_f32_16x16x32_bf16 v[132:135], a[244:247], a[128:131], v[132:135]
 ds_read_b64_tr_b16 a[224:225], v21 offset:24576
 v_mfma_f32_16x16x32_bf16 v[148:151], a[244:247], a[132:135], v[148:151]
 ds_read_b64_tr_b16 a[226:227], v21 offset:25088
 v_mfma_f32_16x16x32_bf16 v[164:167], a[244:247], a[136:139], v[164:167]
 v_mfma_f32_16x16x32_bf16 v[180:183], a[244:247], a[140:143], v[180:183]
 buffer_load_dwordx4 v4, s[40:43], s83 offen offset:1024 lds
 s_waitcnt lgkmcnt(2)
 v_mfma_f32_16x16x32_bf16 v[136:139], a[248:251], a[128:131], v[136:139]
 ds_read_b64_tr_b16 a[228:229], v22 offset:24576
 v_mfma_f32_16x16x32_bf16 v[152:155], a[248:251], a[132:135], v[152:155]
 ds_read_b64_tr_b16 a[230:231], v22 offset:25088
 v_mfma_f32_16x16x32_bf16 v[168:171], a[248:251], a[136:139], v[168:171]
 s_add_u32 m0, s81, 106496
 s_mov_b32 s10, 924672
 v_mfma_f32_16x16x32_bf16 v[184:187], a[248:251], a[140:143], v[184:187]
 buffer_load_dwordx4 v60, s[52:55], s10 offen offset:0 lds
 v_mfma_f32_16x16x32_bf16 v[140:143], a[252:255], a[128:131], v[140:143]
 ds_read_b64_tr_b16 a[232:233], v21 offset:25600
 v_mfma_f32_16x16x32_bf16 v[156:159], a[252:255], a[132:135], v[156:159]
 ds_read_b64_tr_b16 a[234:235], v21 offset:26112
 v_mfma_f32_16x16x32_bf16 v[172:175], a[252:255], a[136:139], v[172:175]
 v_mfma_f32_16x16x32_bf16 v[188:191], a[252:255], a[140:143], v[188:191]
 buffer_load_dwordx4 v61, s[52:55], s10 offen offset:1024 lds
 s_waitcnt lgkmcnt(2)
 v_mfma_f32_16x16x32_bf16 v[128:131], a[224:227], a[144:147], v[128:131]
 ds_read_b64_tr_b16 a[236:237], v22 offset:25600
 v_mfma_f32_16x16x32_bf16 v[144:147], a[224:227], a[148:151], v[144:147]
 ds_read_b64_tr_b16 a[238:239], v22 offset:26112
 v_mfma_f32_16x16x32_bf16 v[160:163], a[224:227], a[152:155], v[160:163]
 s_add_u32 m0, s81, 73728
 s_mov_b32 s10, 1146880
 v_mfma_f32_16x16x32_bf16 v[176:179], a[224:227], a[156:159], v[176:179]
 buffer_load_dwordx4 v60, s[52:55], s10 offen offset:0 lds
 v_mfma_f32_16x16x32_bf16 v[132:135], a[228:231], a[144:147], v[132:135]
 s_waitcnt vmcnt(11)
 s_barrier
 s_bitcmp1_b32 8, s78
 s_cbranch_scc0 L_tch12
 buffer_load_dword v16, v16, s[68:71], 0 offen
L_tch12:
 ds_read_b64_tr_b16 a[240:241], v25 offset:32768
 v_mfma_f32_16x16x32_bf16 v[148:151], a[228:231], a[148:151], v[148:151]
 ds_read_b64_tr_b16 a[242:243], v25 offset:33280
 v_mfma_f32_16x16x32_bf16 v[164:167], a[228:231], a[152:155], v[164:167]
 v_mfma_f32_16x16x32_bf16 v[180:183], a[228:231], a[156:159], v[180:183]
 s_waitcnt lgkmcnt(2)
 v_mfma_f32_16x16x32_bf16 v[136:139], a[232:235], a[144:147], v[136:139]
 buffer_load_dwordx4 v61, s[52:55], s10 offen offset:1024 lds
 ds_read_b64_tr_b16 a[244:245], v26 offset:32768
 v_mfma_f32_16x16x32_bf16 v[152:155], a[232:235], a[148:151], v[152:155]
 ds_read_b64_tr_b16 a[246:247], v26 offset:33280
 v_mfma_f32_16x16x32_bf16 v[168:171], a[232:235], a[152:155], v[168:171]
 v_mfma_f32_16x16x32_bf16 v[184:187], a[232:235], a[156:159], v[184:187]
 s_add_u32 m0, s81, 114688
 s_mul_i32 s83, s94, 1792
 s_addk_i32 s83, 128
 v_mfma_f32_16x16x32_bf16 v[140:143], a[236:239], a[144:147], v[140:143]
 buffer_load_dwordx4 v4, s[36:39], s83 offen offset:0 lds
 ds_read_b64_tr_b16 a[248:249], v25 offset:33792
 v_mfma_f32_16x16x32_bf16 v[156:159], a[236:239], a[148:151], v[156:159]
 ds_read_b64_tr_b16 a[250:251], v25 offset:34304
 v_mfma_f32_16x16x32_bf16 v[172:175], a[236:239], a[152:155], v[172:175]
 v_mfma_f32_16x16x32_bf16 v[188:191], a[236:239], a[156:159], v[188:191]
 s_waitcnt lgkmcnt(2)
 v_mfma_f32_16x16x32_bf16 v[128:131], a[240:243], a[160:163], v[128:131]
 buffer_load_dwordx4 v4, s[40:43], s83 offen offset:1024 lds
 ds_read_b64_tr_b16 a[252:253], v26 offset:33792
 v_mfma_f32_16x16x32_bf16 v[144:147], a[240:243], a[164:167], v[144:147]
 ds_read_b64_tr_b16 a[254:255], v26 offset:34304
 v_mfma_f32_16x16x32_bf16 v[160:163], a[240:243], a[168:171], v[160:163]
 v_mfma_f32_16x16x32_bf16 v[176:179], a[240:243], a[172:175], v[176:179]
 s_add_u32 m0, s81, 122880
 s_add_u32 s83, s83, 114688
 v_mfma_f32_16x16x32_bf16 v[132:135], a[244:247], a[160:163], v[132:135]
 buffer_load_dwordx4 v4, s[36:39], s83 offen offset:0 lds
 ds_read_b64_tr_b16 a[224:225], v21 offset:32768
 v_mfma_f32_16x16x32_bf16 v[148:151], a[244:247], a[164:167], v[148:151]
 ds_read_b64_tr_b16 a[226:227], v21 offset:33280
 v_mfma_f32_16x16x32_bf16 v[164:167], a[244:247], a[168:171], v[164:167]
 v_mfma_f32_16x16x32_bf16 v[180:183], a[244:247], a[172:175], v[180:183]
 s_waitcnt lgkmcnt(2)
 v_mfma_f32_16x16x32_bf16 v[136:139], a[248:251], a[160:163], v[136:139]
 buffer_load_dwordx4 v4, s[40:43], s83 offen offset:1024 lds
 ds_read_b64_tr_b16 a[228:229], v22 offset:32768
 v_mfma_f32_16x16x32_bf16 v[152:155], a[248:251], a[164:167], v[152:155]
 ds_read_b64_tr_b16 a[230:231], v22 offset:33280
 v_mfma_f32_16x16x32_bf16 v[168:171], a[248:251], a[168:171], v[168:171]
 v_mfma_f32_16x16x32_bf16 v[184:187], a[248:251], a[172:175], v[184:187]
 s_add_u32 m0, s81, 131072
 s_mov_b32 s10, 1154048
 v_mfma_f32_16x16x32_bf16 v[140:143], a[252:255], a[160:163], v[140:143]
 buffer_load_dwordx4 v60, s[52:55], s10 offen offset:0 lds
 ds_read_b64_tr_b16 a[232:233], v21 offset:33792
 v_mfma_f32_16x16x32_bf16 v[156:159], a[252:255], a[164:167], v[156:159]
 ds_read_b64_tr_b16 a[234:235], v21 offset:34304
 v_mfma_f32_16x16x32_bf16 v[172:175], a[252:255], a[168:171], v[172:175]
 v_mfma_f32_16x16x32_bf16 v[188:191], a[252:255], a[172:175], v[188:191]
 s_waitcnt lgkmcnt(2)
 v_mfma_f32_16x16x32_bf16 v[128:131], a[224:227], a[176:179], v[128:131]
 buffer_load_dwordx4 v61, s[52:55], s10 offen offset:1024 lds
 ds_read_b64_tr_b16 a[236:237], v22 offset:33792
 v_mfma_f32_16x16x32_bf16 v[144:147], a[224:227], a[180:183], v[144:147]
 ds_read_b64_tr_b16 a[238:239], v22 offset:34304
 v_mfma_f32_16x16x32_bf16 v[160:163], a[224:227], a[184:187], v[160:163]
 v_mfma_f32_16x16x32_bf16 v[176:179], a[224:227], a[188:191], v[176:179]
 s_add_u32 m0, s81, 139264
 s_mov_b32 s10, 1376256
 v_mfma_f32_16x16x32_bf16 v[132:135], a[228:231], a[176:179], v[132:135]
 buffer_load_dwordx4 v60, s[52:55], s10 offen offset:0 lds
 s_waitcnt vmcnt(11)
 s_barrier
 ds_read_b64_tr_b16 a[240:241], v21 offset:40960
 v_mfma_f32_16x16x32_bf16 v[148:151], a[228:231], a[180:183], v[148:151]
 ds_read_b64_tr_b16 a[242:243], v21 offset:41472
 v_mfma_f32_16x16x32_bf16 v[164:167], a[228:231], a[184:187], v[164:167]
 buffer_load_dwordx4 v61, s[52:55], s10 offen offset:1024 lds
 v_mfma_f32_16x16x32_bf16 v[180:183], a[228:231], a[188:191], v[180:183]
 s_waitcnt lgkmcnt(2)
 v_mfma_f32_16x16x32_bf16 v[136:139], a[232:235], a[176:179], v[136:139]
 ds_read_b64_tr_b16 a[244:245], v22 offset:40960
 v_mfma_f32_16x16x32_bf16 v[152:155], a[232:235], a[180:183], v[152:155]
 ds_read_b64_tr_b16 a[246:247], v22 offset:41472
 s_add_u32 m0, s81, 147456
 s_add_u32 s83, s83, 114688
 v_mfma_f32_16x16x32_bf16 v[168:171], a[232:235], a[184:187], v[168:171]
 s_cmp_eq_u32 s83, 1605760
 s_cselect_b32 s83, 128, s83
 v_mfma_f32_16x16x32_bf16 v[184:187], a[232:235], a[188:191], v[184:187]
 buffer_load_dwordx4 v4, s[36:39], s83 offen offset:0 lds
 v_mfma_f32_16x16x32_bf16 v[140:143], a[236:239], a[176:179], v[140:143]
 ds_read_b64_tr_b16 a[248:249], v21 offset:41984
 v_mfma_f32_16x16x32_bf16 v[156:159], a[236:239], a[180:183], v[156:159]
 ds_read_b64_tr_b16 a[250:251], v21 offset:42496
 v_mfma_f32_16x16x32_bf16 v[172:175], a[236:239], a[184:187], v[172:175]
 v_mfma_f32_16x16x32_bf16 v[188:191], a[236:239], a[188:191], v[188:191]
 buffer_load_dwordx4 v4, s[40:43], s83 offen offset:1024 lds
 s_waitcnt lgkmcnt(2)
 v_mfma_f32_16x16x32_bf16 v[128:131], a[240:243], a[192:195], v[128:131]
 ds_read_b64_tr_b16 a[252:253], v22 offset:41984
 v_mfma_f32_16x16x32_bf16 v[144:147], a[240:243], a[196:199], v[144:147]
 ds_read_b64_tr_b16 a[254:255], v22 offset:42496
 v_mfma_f32_16x16x32_bf16 v[160:163], a[240:243], a[200:203], v[160:163]
 s_add_u32 m0, s81, 81920
 s_add_u32 s83, s83, 114688
 v_mfma_f32_16x16x32_bf16 v[176:179], a[240:243], a[204:207], v[176:179]
 buffer_load_dwordx4 v4, s[36:39], s83 offen offset:0 lds
 v_mfma_f32_16x16x32_bf16 v[132:135], a[244:247], a[192:195], v[132:135]
 ds_read_b64_tr_b16 a[224:225], v25 offset:0
 v_mfma_f32_16x16x32_bf16 v[148:151], a[244:247], a[196:199], v[148:151]
 ds_read_b64_tr_b16 a[226:227], v25 offset:512
 v_mfma_f32_16x16x32_bf16 v[164:167], a[244:247], a[200:203], v[164:167]
 v_mfma_f32_16x16x32_bf16 v[180:183], a[244:247], a[204:207], v[180:183]
 buffer_load_dwordx4 v4, s[40:43], s83 offen offset:1024 lds
 s_waitcnt lgkmcnt(2)
 v_mfma_f32_16x16x32_bf16 v[136:139], a[248:251], a[192:195], v[136:139]
 ds_read_b64_tr_b16 a[228:229], v26 offset:0
 v_mfma_f32_16x16x32_bf16 v[152:155], a[248:251], a[196:199], v[152:155]
 ds_read_b64_tr_b16 a[230:231], v26 offset:512
 v_mfma_f32_16x16x32_bf16 v[168:171], a[248:251], a[200:203], v[168:171]
 s_add_u32 m0, s81, 0
 s_mov_b32 s10, 1383424
 v_mfma_f32_16x16x32_bf16 v[184:187], a[248:251], a[204:207], v[184:187]
 buffer_load_dwordx4 v60, s[52:55], s10 offen offset:0 lds
 v_mfma_f32_16x16x32_bf16 v[140:143], a[252:255], a[192:195], v[140:143]
 ds_read_b64_tr_b16 a[232:233], v25 offset:1024
 v_mfma_f32_16x16x32_bf16 v[156:159], a[252:255], a[196:199], v[156:159]
 ds_read_b64_tr_b16 a[234:235], v25 offset:1536
 v_mfma_f32_16x16x32_bf16 v[172:175], a[252:255], a[200:203], v[172:175]
 v_mfma_f32_16x16x32_bf16 v[188:191], a[252:255], a[204:207], v[188:191]
 buffer_load_dwordx4 v61, s[52:55], s10 offen offset:1024 lds
 s_waitcnt lgkmcnt(2)
 v_mfma_f32_16x16x32_bf16 v[128:131], a[224:227], a[208:211], v[128:131]
 ds_read_b64_tr_b16 a[236:237], v26 offset:1024
 v_mfma_f32_16x16x32_bf16 v[144:147], a[224:227], a[212:215], v[144:147]
 ds_read_b64_tr_b16 a[238:239], v26 offset:1536
 v_mfma_f32_16x16x32_bf16 v[160:163], a[224:227], a[216:219], v[160:163]
 s_add_u32 m0, s81, 16384
 s_mov_b32 s10, 57344
 v_mfma_f32_16x16x32_bf16 v[176:179], a[224:227], a[220:223], v[176:179]
 buffer_load_dwordx4 v60, s[52:55], s10 offen offset:0 lds
 v_mfma_f32_16x16x32_bf16 v[132:135], a[228:231], a[208:211], v[132:135]
 s_waitcnt vmcnt(11)
 s_barrier
 ds_read_b64_tr_b16 a[240:241], v25 offset:49152
 v_mfma_f32_16x16x32_bf16 v[148:151], a[228:231], a[212:215], v[148:151]
 ds_read_b64_tr_b16 a[242:243], v25 offset:49664
 v_mfma_f32_16x16x32_bf16 v[164:167], a[228:231], a[216:219], v[164:167]
 buffer_load_dwordx4 v61, s[52:55], s10 offen offset:1024 lds
 v_mfma_f32_16x16x32_bf16 v[180:183], a[228:231], a[220:223], v[180:183]
 s_waitcnt lgkmcnt(2)
 v_mfma_f32_16x16x32_bf16 v[136:139], a[232:235], a[208:211], v[136:139]
 ds_read_b64_tr_b16 a[244:245], v26 offset:49152
 v_mfma_f32_16x16x32_bf16 v[152:155], a[232:235], a[212:215], v[152:155]
 ds_read_b64_tr_b16 a[246:247], v26 offset:49664
 s_add_u32 m0, s81, 24576
 s_add_u32 s83, s83, 114688
 v_mfma_f32_16x16x32_bf16 v[168:171], a[232:235], a[216:219], v[168:171]
 s_cmp_eq_u32 s83, 1605760
 s_cselect_b32 s83, 128, s83
 v_mfma_f32_16x16x32_bf16 v[184:187], a[232:235], a[220:223], v[184:187]
 buffer_load_dwordx4 v4, s[36:39], s83 offen offset:0 lds
 v_mfma_f32_16x16x32_bf16 v[140:143], a[236:239], a[208:211], v[140:143]
 ds_read_b64_tr_b16 a[248:249], v25 offset:50176
 v_mfma_f32_16x16x32_bf16 v[156:159], a[236:239], a[212:215], v[156:159]
 ds_read_b64_tr_b16 a[250:251], v25 offset:50688
 v_mfma_f32_16x16x32_bf16 v[172:175], a[236:239], a[216:219], v[172:175]
 v_mfma_f32_16x16x32_bf16 v[188:191], a[236:239], a[220:223], v[188:191]
 buffer_load_dwordx4 v4, s[40:43], s83 offen offset:1024 lds
 s_waitcnt lgkmcnt(2)
 v_mfma_f32_16x16x32_bf16 v[192:195], a[240:243], a[0:3], 0
 ds_read_b64_tr_b16 a[252:253], v26 offset:50176
 v_mfma_f32_16x16x32_bf16 v[208:211], a[240:243], a[4:7], 0
 ds_read_b64_tr_b16 a[254:255], v26 offset:50688
 v_mfma_f32_16x16x32_bf16 v[224:227], a[240:243], a[8:11], 0
 s_add_u32 m0, s81, 98304
 s_add_u32 s83, s83, 114688
 v_mfma_f32_16x16x32_bf16 v[240:243], a[240:243], a[12:15], 0
 buffer_load_dwordx4 v4, s[36:39], s83 offen offset:0 lds
 v_mfma_f32_16x16x32_bf16 v[196:199], a[244:247], a[0:3], 0
 ds_read_b64_tr_b16 a[224:225], v25 offset:57344
 v_max_f32 v128, 0, v128
 v_max_f32 v129, 0, v129
 v_max_f32 v130, 0, v130
 v_max_f32 v131, 0, v131
 v_mfma_f32_16x16x32_bf16 v[212:215], a[244:247], a[4:7], 0
 ds_read_b64_tr_b16 a[226:227], v25 offset:57856
 v_max_f32 v132, 0, v132
 v_max_f32 v133, 0, v133
 v_max_f32 v134, 0, v134
 v_max_f32 v135, 0, v135
 v_mfma_f32_16x16x32_bf16 v[228:231], a[244:247], a[8:11], 0
 buffer_load_dwordx4 v4, s[40:43], s83 offen offset:1024 lds
 v_mul_f32 v128, v128, v136
 v_mul_f32 v129, v129, v137
 v_mul_f32 v130, v130, v138
 v_mul_f32 v131, v131, v139
 v_mfma_f32_16x16x32_bf16 v[244:247], a[244:247], a[12:15], 0
 v_mul_f32 v132, v132, v140
 v_mul_f32 v133, v133, v141
 v_mul_f32 v134, v134, v142
 v_mul_f32 v135, v135, v143
 s_waitcnt lgkmcnt(2)
 v_mfma_f32_16x16x32_bf16 v[200:203], a[248:251], a[0:3], 0
 ds_read_b64_tr_b16 a[228:229], v26 offset:57344
 v_cvt_pk_bf16_f32 v136, v128, v129
 v_cvt_pk_bf16_f32 v137, v130, v131
 v_cvt_pk_bf16_f32 v138, v132, v133
 v_cvt_pk_bf16_f32 v139, v134, v135
 v_mfma_f32_16x16x32_bf16 v[216:219], a[248:251], a[4:7], 0
 ds_read_b64_tr_b16 a[230:231], v26 offset:57856
 s_movk_i32 s88, 0
 v_mfma_f32_16x16x32_bf16 v[232:235], a[248:251], a[8:11], 0
 buffer_store_dwordx4 v[136:139], v8, s[44:47], s88 offen offset:0 sc1
 v_max_f32 v144, 0, v144
 v_max_f32 v145, 0, v145
 v_max_f32 v146, 0, v146
 v_max_f32 v147, 0, v147
 v_mfma_f32_16x16x32_bf16 v[248:251], a[248:251], a[12:15], 0
 v_max_f32 v148, 0, v148
 v_max_f32 v149, 0, v149
 v_max_f32 v150, 0, v150
 v_max_f32 v151, 0, v151
 v_mul_f32 v144, v144, v152
 v_mfma_f32_16x16x32_bf16 v[204:207], a[252:255], a[0:3], 0
 ds_read_b64_tr_b16 a[232:233], v25 offset:58368
 v_mul_f32 v145, v145, v153
 v_mul_f32 v146, v146, v154
 v_mul_f32 v147, v147, v155
 v_mul_f32 v148, v148, v156
 v_mfma_f32_16x16x32_bf16 v[220:223], a[252:255], a[4:7], 0
 ds_read_b64_tr_b16 a[234:235], v25 offset:58880
 v_mul_f32 v149, v149, v157
 v_mul_f32 v150, v150, v158
 v_mul_f32 v151, v151, v159
 v_cvt_pk_bf16_f32 v152, v144, v145
 v_mfma_f32_16x16x32_bf16 v[236:239], a[252:255], a[8:11], 0
 v_cvt_pk_bf16_f32 v153, v146, v147
 v_cvt_pk_bf16_f32 v154, v148, v149
 v_cvt_pk_bf16_f32 v155, v150, v151
 v_mfma_f32_16x16x32_bf16 v[252:255], a[252:255], a[12:15], 0
 buffer_store_dwordx4 v[152:155], v8, s[44:47], s88 offen offset:256 sc1
 v_max_f32 v160, 0, v160
 v_max_f32 v161, 0, v161
 v_max_f32 v162, 0, v162
 s_waitcnt lgkmcnt(2)
 v_mfma_f32_16x16x32_bf16 v[192:195], a[224:227], a[16:19], v[192:195]
 ds_read_b64_tr_b16 a[236:237], v26 offset:58368
 v_max_f32 v163, 0, v163
 v_max_f32 v164, 0, v164
 v_max_f32 v165, 0, v165
 v_max_f32 v166, 0, v166
 v_mfma_f32_16x16x32_bf16 v[208:211], a[224:227], a[20:23], v[208:211]
 ds_read_b64_tr_b16 a[238:239], v26 offset:58880
 v_max_f32 v167, 0, v167
 v_mul_f32 v160, v160, v168
 v_mul_f32 v161, v161, v169
 v_mul_f32 v162, v162, v170
 v_mfma_f32_16x16x32_bf16 v[224:227], a[224:227], a[24:27], v[224:227]
 ds_read_b64_tr_b16 a[0:1], v71 offset:24576
 ds_read_b64_tr_b16 a[2:3], v71 offset:25600
 v_mul_f32 v163, v163, v171
 v_mul_f32 v164, v164, v172
 v_mul_f32 v165, v165, v173
 v_mfma_f32_16x16x32_bf16 v[240:243], a[224:227], a[28:31], v[240:243]
 ds_read_b64_tr_b16 a[4:5], v72 offset:24576
 ds_read_b64_tr_b16 a[6:7], v72 offset:25600
 v_mul_f32 v166, v166, v174
 v_mul_f32 v167, v167, v175
 v_cvt_pk_bf16_f32 v168, v160, v161
 v_mfma_f32_16x16x32_bf16 v[196:199], a[228:231], a[16:19], v[196:199]
 s_waitcnt vmcnt(10)
 s_barrier
 ds_read_b64_tr_b16 a[240:241], v29 offset:16384
 v_mfma_f32_16x16x32_bf16 v[212:215], a[228:231], a[20:23], v[212:215]
 ds_read_b64_tr_b16 a[242:243], v29 offset:16896
 s_add_u32 m0, s81, 32768
 s_add_u32 s83, s83, 114688
 s_cmp_eq_u32 s83, 1605760
 s_cselect_b32 s83, 128, s83
 v_mfma_f32_16x16x32_bf16 v[228:231], a[228:231], a[24:27], v[228:231]
 buffer_load_dwordx4 v4, s[36:39], s83 offen offset:0 lds
 v_cvt_pk_bf16_f32 v169, v162, v163
 v_cvt_pk_bf16_f32 v170, v164, v165
 v_cvt_pk_bf16_f32 v171, v166, v167
 v_mfma_f32_16x16x32_bf16 v[244:247], a[228:231], a[28:31], v[244:247]
 buffer_store_dwordx4 v[168:171], v8, s[44:47], s88 offen offset:1024 sc1
 v_max_f32 v176, 0, v176
 v_max_f32 v177, 0, v177
 v_max_f32 v178, 0, v178
 s_waitcnt lgkmcnt(6)
 v_mfma_f32_16x16x32_bf16 v[200:203], a[232:235], a[16:19], v[200:203]
 ds_read_b64_tr_b16 a[244:245], v30 offset:16384
 v_max_f32 v179, 0, v179
 v_max_f32 v180, 0, v180
 v_max_f32 v181, 0, v181
 v_max_f32 v182, 0, v182
 v_mfma_f32_16x16x32_bf16 v[216:219], a[232:235], a[20:23], v[216:219]
 ds_read_b64_tr_b16 a[246:247], v30 offset:16896
 v_max_f32 v183, 0, v183
 v_mul_f32 v176, v176, v184
 v_mul_f32 v177, v177, v185
 v_mul_f32 v178, v178, v186
 v_mfma_f32_16x16x32_bf16 v[232:235], a[232:235], a[24:27], v[232:235]
 buffer_load_dwordx4 v4, s[40:43], s83 offen offset:1024 lds
 v_mul_f32 v179, v179, v187
 v_mul_f32 v180, v180, v188
 v_mul_f32 v181, v181, v189
 v_mul_f32 v182, v182, v190
 v_mfma_f32_16x16x32_bf16 v[248:251], a[232:235], a[28:31], v[248:251]
 ds_read_b64_tr_b16 a[8:9], v73 offset:24576
 ds_read_b64_tr_b16 a[10:11], v73 offset:25600
 v_mul_f32 v183, v183, v191
 v_cvt_pk_bf16_f32 v184, v176, v177
 v_cvt_pk_bf16_f32 v185, v178, v179
 v_mfma_f32_16x16x32_bf16 v[204:207], a[236:239], a[16:19], v[204:207]
 ds_read_b64_tr_b16 a[248:249], v29 offset:17408
 s_add_u32 m0, s81, 40960
 s_add_u32 s83, s83, 114688
 v_cvt_pk_bf16_f32 v186, v180, v181
 v_cvt_pk_bf16_f32 v187, v182, v183
 v_mfma_f32_16x16x32_bf16 v[220:223], a[236:239], a[20:23], v[220:223]
 buffer_load_dwordx4 v4, s[36:39], s83 offen offset:0 lds
 ds_read_b64_tr_b16 a[250:251], v29 offset:17920
 v_mfma_f32_16x16x32_bf16 v[236:239], a[236:239], a[24:27], v[236:239]
 ds_read_b64_tr_b16 a[12:13], v74 offset:24576
 ds_read_b64_tr_b16 a[14:15], v74 offset:25600
 v_mfma_f32_16x16x32_bf16 v[252:255], a[236:239], a[28:31], v[252:255]
 buffer_store_dwordx4 v[184:187], v8, s[44:47], s88 offen offset:1280 sc1
 s_waitcnt lgkmcnt(6)
 v_mfma_f32_16x16x32_bf16 v[192:195], a[240:243], a[32:35], v[192:195]
 ds_read_b64_tr_b16 a[252:253], v30 offset:17408
 v_mfma_f32_16x16x32_bf16 v[208:211], a[240:243], a[36:39], v[208:211]
 ds_read_b64_tr_b16 a[254:255], v30 offset:17920
 v_mfma_f32_16x16x32_bf16 v[224:227], a[240:243], a[40:43], v[224:227]
 ds_read_b64_tr_b16 a[16:17], v69 offset:49152
 ds_read_b64_tr_b16 a[18:19], v69 offset:50176
 v_mfma_f32_16x16x32_bf16 v[240:243], a[240:243], a[44:47], v[240:243]
 buffer_load_dwordx4 v4, s[40:43], s83 offen offset:1024 lds
 v_mfma_f32_16x16x32_bf16 v[196:199], a[244:247], a[32:35], v[196:199]
 ds_read_b64_tr_b16 a[224:225], v25 offset:16384
 v_mfma_f32_16x16x32_bf16 v[212:215], a[244:247], a[36:39], v[212:215]
 ds_read_b64_tr_b16 a[226:227], v25 offset:16896
 v_mfma_f32_16x16x32_bf16 v[228:231], a[244:247], a[40:43], v[228:231]
 ds_read_b64_tr_b16 a[20:21], v70 offset:49152
 ds_read_b64_tr_b16 a[22:23], v70 offset:50176
 s_add_u32 m0, s81, 90112
 v_mfma_f32_16x16x32_bf16 v[244:247], a[244:247], a[44:47], v[244:247]
 ds_read_b64_tr_b16 a[24:25], v69 offset:57344
 ds_read_b64_tr_b16 a[26:27], v69 offset:58368
 s_waitcnt lgkmcnt(8)
 v_mfma_f32_16x16x32_bf16 v[200:203], a[248:251], a[32:35], v[200:203]
 ds_read_b64_tr_b16 a[228:229], v26 offset:16384
 s_mov_b32 s10, 64512
 v_mfma_f32_16x16x32_bf16 v[216:219], a[248:251], a[36:39], v[216:219]
 buffer_load_dwordx4 v60, s[52:55], s10 offen offset:0 lds
 ds_read_b64_tr_b16 a[230:231], v26 offset:16896
 v_mfma_f32_16x16x32_bf16 v[232:235], a[248:251], a[40:43], v[232:235]
 ds_read_b64_tr_b16 a[28:29], v70 offset:57344
 ds_read_b64_tr_b16 a[30:31], v70 offset:58368
 v_mfma_f32_16x16x32_bf16 v[248:251], a[248:251], a[44:47], v[248:251]
 v_mfma_f32_16x16x32_bf16 v[204:207], a[252:255], a[32:35], v[204:207]
 ds_read_b64_tr_b16 a[232:233], v25 offset:17408
 v_mfma_f32_16x16x32_bf16 v[220:223], a[252:255], a[36:39], v[220:223]
 buffer_load_dwordx4 v61, s[52:55], s10 offen offset:1024 lds
 ds_read_b64_tr_b16 a[234:235], v25 offset:17920
 v_mfma_f32_16x16x32_bf16 v[236:239], a[252:255], a[40:43], v[236:239]
 v_mfma_f32_16x16x32_bf16 v[252:255], a[252:255], a[44:47], v[252:255]
 s_waitcnt lgkmcnt(4)
 v_mfma_f32_16x16x32_bf16 v[192:195], a[224:227], a[48:51], v[192:195]
 ds_read_b64_tr_b16 a[236:237], v26 offset:17408
 s_add_u32 m0, s81, 155648
 s_mov_b32 s10, 286720
 v_mfma_f32_16x16x32_bf16 v[208:211], a[224:227], a[52:55], v[208:211]
 buffer_load_dwordx4 v60, s[52:55], s10 offen offset:0 lds
 ds_read_b64_tr_b16 a[238:239], v26 offset:17920
 v_mfma_f32_16x16x32_bf16 v[224:227], a[224:227], a[56:59], v[224:227]
 ds_read_b64_tr_b16 a[32:33], v69 offset:8192
 ds_read_b64_tr_b16 a[34:35], v69 offset:9216
 v_mfma_f32_16x16x32_bf16 v[240:243], a[224:227], a[60:63], v[240:243]
 ds_read_b64_tr_b16 a[36:37], v70 offset:8192
 ds_read_b64_tr_b16 a[38:39], v70 offset:9216
 v_mfma_f32_16x16x32_bf16 v[196:199], a[228:231], a[48:51], v[196:199]
 buffer_load_dwordx4 v61, s[52:55], s10 offen offset:1024 lds
 s_waitcnt vmcnt(12)
 s_barrier
 ds_read_b64_tr_b16 a[240:241], v21 offset:24576
 v_mfma_f32_16x16x32_bf16 v[212:215], a[228:231], a[52:55], v[212:215]
 ds_read_b64_tr_b16 a[242:243], v21 offset:25088
 s_add_u32 m0, s81, 65536
 s_add_u32 s83, s83, 114688
 v_mfma_f32_16x16x32_bf16 v[228:231], a[228:231], a[56:59], v[228:231]
 ds_read_b64_tr_b16 a[40:41], v71 offset:40960
 ds_read_b64_tr_b16 a[42:43], v71 offset:41984
 s_cmp_eq_u32 s83, 1605760
 s_cselect_b32 s83, 128, s83
 v_mfma_f32_16x16x32_bf16 v[244:247], a[228:231], a[60:63], v[244:247]
 buffer_load_dwordx4 v4, s[36:39], s83 offen offset:0 lds
 s_waitcnt lgkmcnt(8)
 v_mfma_f32_16x16x32_bf16 v[200:203], a[232:235], a[48:51], v[200:203]
 ds_read_b64_tr_b16 a[244:245], v22 offset:24576
 v_mfma_f32_16x16x32_bf16 v[216:219], a[232:235], a[52:55], v[216:219]
 ds_read_b64_tr_b16 a[246:247], v22 offset:25088
 v_mfma_f32_16x16x32_bf16 v[232:235], a[232:235], a[56:59], v[232:235]
 ds_read_b64_tr_b16 a[44:45], v72 offset:40960
 ds_read_b64_tr_b16 a[46:47], v72 offset:41984
 v_mfma_f32_16x16x32_bf16 v[248:251], a[232:235], a[60:63], v[248:251]
 buffer_load_dwordx4 v4, s[40:43], s83 offen offset:1024 lds
 v_mfma_f32_16x16x32_bf16 v[204:207], a[236:239], a[48:51], v[204:207]
 s_waitcnt vmcnt(7)
 s_barrier
 s_cmp_eq_u32 s72, 0
 s_cbranch_scc0 L_sigA
 buffer_store_dword v13, v33, s[44:47], s27 offen sc1
L_sigA:
 ds_read_b64_tr_b16 a[248:249], v21 offset:25600
 v_mfma_f32_16x16x32_bf16 v[220:223], a[236:239], a[52:55], v[220:223]
 ds_read_b64_tr_b16 a[250:251], v21 offset:26112
 v_mfma_f32_16x16x32_bf16 v[236:239], a[236:239], a[56:59], v[236:239]
 v_mfma_f32_16x16x32_bf16 v[252:255], a[236:239], a[60:63], v[252:255]
 s_add_u32 m0, s81, 114688
 s_add_u32 s83, s83, 114688
 s_waitcnt lgkmcnt(4)
 v_mfma_f32_16x16x32_bf16 v[192:195], a[240:243], a[64:67], v[192:195]
 buffer_load_dwordx4 v4, s[36:39], s83 offen offset:0 lds
 ds_read_b64_tr_b16 a[252:253], v22 offset:25600
 v_mfma_f32_16x16x32_bf16 v[208:211], a[240:243], a[68:71], v[208:211]
 ds_read_b64_tr_b16 a[254:255], v22 offset:26112
 v_mfma_f32_16x16x32_bf16 v[224:227], a[240:243], a[72:75], v[224:227]
 ds_read_b64_tr_b16 a[48:49], v71 offset:8192
 ds_read_b64_tr_b16 a[50:51], v71 offset:9216
 v_mfma_f32_16x16x32_bf16 v[240:243], a[240:243], a[76:79], v[240:243]
 ds_read_b64_tr_b16 a[52:53], v72 offset:8192
 ds_read_b64_tr_b16 a[54:55], v72 offset:9216
 v_mfma_f32_16x16x32_bf16 v[196:199], a[244:247], a[64:67], v[196:199]
 buffer_load_dwordx4 v4, s[40:43], s83 offen offset:1024 lds
 ds_read_b64_tr_b16 a[224:225], v25 offset:32768
 v_mfma_f32_16x16x32_bf16 v[212:215], a[244:247], a[68:71], v[212:215]
 ds_read_b64_tr_b16 a[226:227], v25 offset:33280
 v_mfma_f32_16x16x32_bf16 v[228:231], a[244:247], a[72:75], v[228:231]
 ds_read_b64_tr_b16 a[56:57], v73 offset:0
 ds_read_b64_tr_b16 a[58:59], v73 offset:1024
 v_mfma_f32_16x16x32_bf16 v[244:247], a[244:247], a[76:79], v[244:247]
 ds_read_b64_tr_b16 a[60:61], v74 offset:0
 ds_read_b64_tr_b16 a[62:63], v74 offset:1024
 s_waitcnt lgkmcnt(10)
 v_mfma_f32_16x16x32_bf16 v[200:203], a[248:251], a[64:67], v[200:203]
 ds_read_b64_tr_b16 a[228:229], v26 offset:32768
 s_add_u32 m0, s81, 49152
 s_mov_b32 s10, 293888
 v_mfma_f32_16x16x32_bf16 v[216:219], a[248:251], a[68:71], v[216:219]
 buffer_load_dwordx4 v60, s[52:55], s10 offen offset:0 lds
 ds_read_b64_tr_b16 a[230:231], v26 offset:33280
 v_mfma_f32_16x16x32_bf16 v[232:235], a[248:251], a[72:75], v[232:235]
 v_mfma_f32_16x16x32_bf16 v[248:251], a[248:251], a[76:79], v[248:251]
 v_mfma_f32_16x16x32_bf16 v[204:207], a[252:255], a[64:67], v[204:207]
 ds_read_b64_tr_b16 a[232:233], v25 offset:33792
 v_mfma_f32_16x16x32_bf16 v[220:223], a[252:255], a[68:71], v[220:223]
 buffer_load_dwordx4 v61, s[52:55], s10 offen offset:1024 lds
 ds_read_b64_tr_b16 a[234:235], v25 offset:34304
 v_mfma_f32_16x16x32_bf16 v[236:239], a[252:255], a[72:75], v[236:239]
 v_mfma_f32_16x16x32_bf16 v[252:255], a[252:255], a[76:79], v[252:255]
 s_waitcnt lgkmcnt(2)
 v_mfma_f32_16x16x32_bf16 v[192:195], a[224:227], a[80:83], v[192:195]
 ds_read_b64_tr_b16 a[236:237], v26 offset:33792
 s_add_u32 m0, s81, 57344
 s_mov_b32 s10, 516096
 v_mfma_f32_16x16x32_bf16 v[208:211], a[224:227], a[84:87], v[208:211]
 buffer_load_dwordx4 v60, s[52:55], s10 offen offset:0 lds
 ds_read_b64_tr_b16 a[238:239], v26 offset:34304
 v_mfma_f32_16x16x32_bf16 v[224:227], a[224:227], a[88:91], v[224:227]
 ds_read_b64_tr_b16 a[64:65], v73 offset:8192
 ds_read_b64_tr_b16 a[66:67], v73 offset:9216
 v_mfma_f32_16x16x32_bf16 v[240:243], a[224:227], a[92:95], v[240:243]
 ds_read_b64_tr_b16 a[68:69], v74 offset:8192
 ds_read_b64_tr_b16 a[70:71], v74 offset:9216
 v_mfma_f32_16x16x32_bf16 v[196:199], a[228:231], a[80:83], v[196:199]
 buffer_load_dwordx4 v61, s[52:55], s10 offen offset:1024 lds
 s_waitcnt vmcnt(12)
 s_barrier
 ds_read_b64_tr_b16 a[240:241], v21 offset:32768
 v_mfma_f32_16x16x32_bf16 v[212:215], a[228:231], a[84:87], v[212:215]
 ds_read_b64_tr_b16 a[242:243], v21 offset:33280
 s_add_u32 m0, s81, 122880
 s_add_u32 s83, s83, 114688
 v_mfma_f32_16x16x32_bf16 v[228:231], a[228:231], a[88:91], v[228:231]
 ds_read_b64_tr_b16 a[72:73], v69 offset:0
 ds_read_b64_tr_b16 a[74:75], v69 offset:1024
 s_cmp_eq_u32 s83, 1605760
 s_cselect_b32 s83, 128, s83
 v_mfma_f32_16x16x32_bf16 v[244:247], a[228:231], a[92:95], v[244:247]
 buffer_load_dwordx4 v4, s[36:39], s83 offen offset:0 lds
 s_waitcnt lgkmcnt(8)
 v_mfma_f32_16x16x32_bf16 v[200:203], a[232:235], a[80:83], v[200:203]
 ds_read_b64_tr_b16 a[244:245], v22 offset:32768
 v_mfma_f32_16x16x32_bf16 v[216:219], a[232:235], a[84:87], v[216:219]
 ds_read_b64_tr_b16 a[246:247], v22 offset:33280
 v_mfma_f32_16x16x32_bf16 v[232:235], a[232:235], a[88:91], v[232:235]
 ds_read_b64_tr_b16 a[76:77], v70 offset:0
 ds_read_b64_tr_b16 a[78:79], v70 offset:1024
 v_mfma_f32_16x16x32_bf16 v[248:251], a[232:235], a[92:95], v[248:251]
 buffer_load_dwordx4 v4, s[40:43], s83 offen offset:1024 lds
 v_mfma_f32_16x16x32_bf16 v[204:207], a[236:239], a[80:83], v[204:207]
 ds_read_b64_tr_b16 a[248:249], v21 offset:33792
 v_mfma_f32_16x16x32_bf16 v[220:223], a[236:239], a[84:87], v[220:223]
 ds_read_b64_tr_b16 a[250:251], v21 offset:34304
 v_mfma_f32_16x16x32_bf16 v[236:239], a[236:239], a[88:91], v[236:239]
 s_add_u32 m0, s81, 147456
 s_add_u32 s83, s83, 114688
 v_mfma_f32_16x16x32_bf16 v[252:255], a[236:239], a[92:95], v[252:255]
 buffer_load_dwordx4 v4, s[36:39], s83 offen offset:0 lds
 s_waitcnt lgkmcnt(4)
 v_mfma_f32_16x16x32_bf16 v[192:195], a[240:243], a[96:99], v[192:195]
 ds_read_b64_tr_b16 a[252:253], v22 offset:33792
 v_mfma_f32_16x16x32_bf16 v[208:211], a[240:243], a[100:103], v[208:211]
 ds_read_b64_tr_b16 a[254:255], v22 offset:34304
 v_mfma_f32_16x16x32_bf16 v[224:227], a[240:243], a[104:107], v[224:227]
 ds_read_b64_tr_b16 a[80:81], v69 offset:16384
 ds_read_b64_tr_b16 a[82:83], v69 offset:17408
 v_mfma_f32_16x16x32_bf16 v[240:243], a[240:243], a[108:111], v[240:243]
 buffer_load_dwordx4 v4, s[40:43], s83 offen offset:1024 lds
 v_mfma_f32_16x16x32_bf16 v[196:199], a[244:247], a[96:99], v[196:199]
 ds_read_b64_tr_b16 a[224:225], v21 offset:40960
 v_mfma_f32_16x16x32_bf16 v[212:215], a[244:247], a[100:103], v[212:215]
 ds_read_b64_tr_b16 a[226:227], v21 offset:41472
 v_mfma_f32_16x16x32_bf16 v[228:231], a[244:247], a[104:107], v[228:231]
 ds_read_b64_tr_b16 a[84:85], v70 offset:16384
 ds_read_b64_tr_b16 a[86:87], v70 offset:17408
 s_add_u32 m0, s81, 8192
 v_mfma_f32_16x16x32_bf16 v[244:247], a[244:247], a[108:111], v[244:247]
 s_waitcnt vmcnt(14)
 ds_read_b64_tr_b16 a[88:89], v71 offset:24576
 ds_read_b64_tr_b16 a[90:91], v71 offset:25600
 s_waitcnt lgkmcnt(8)
 v_mfma_f32_16x16x32_bf16 v[200:203], a[248:251], a[96:99], v[200:203]
 ds_read_b64_tr_b16 a[228:229], v22 offset:40960
 s_mov_b32 s10, 523264
 v_mfma_f32_16x16x32_bf16 v[216:219], a[248:251], a[100:103], v[216:219]
 buffer_load_dwordx4 v60, s[52:55], s10 offen offset:0 lds
 ds_read_b64_tr_b16 a[230:231], v22 offset:41472
 v_mfma_f32_16x16x32_bf16 v[232:235], a[248:251], a[104:107], v[232:235]
 ds_read_b64_tr_b16 a[92:93], v72 offset:24576
 ds_read_b64_tr_b16 a[94:95], v72 offset:25600
 v_mfma_f32_16x16x32_bf16 v[248:251], a[248:251], a[108:111], v[248:251]
 v_mfma_f32_16x16x32_bf16 v[204:207], a[252:255], a[96:99], v[204:207]
 ds_read_b64_tr_b16 a[232:233], v21 offset:41984
 v_mfma_f32_16x16x32_bf16 v[220:223], a[252:255], a[100:103], v[220:223]
 buffer_load_dwordx4 v61, s[52:55], s10 offen offset:1024 lds
 ds_read_b64_tr_b16 a[234:235], v21 offset:42496
 v_mfma_f32_16x16x32_bf16 v[236:239], a[252:255], a[104:107], v[236:239]
 v_mfma_f32_16x16x32_bf16 v[252:255], a[252:255], a[108:111], v[252:255]
 s_waitcnt lgkmcnt(4)
 v_mfma_f32_16x16x32_bf16 v[192:195], a[224:227], a[112:115], v[192:195]
 ds_read_b64_tr_b16 a[236:237], v22 offset:41984
 s_add_u32 m0, s81, 106496
 s_mov_b32 s10, 745472
 v_mfma_f32_16x16x32_bf16 v[208:211], a[224:227], a[116:119], v[208:211]
 buffer_load_dwordx4 v60, s[52:55], s10 offen offset:0 lds
 ds_read_b64_tr_b16 a[238:239], v22 offset:42496
 v_mfma_f32_16x16x32_bf16 v[224:227], a[224:227], a[120:123], v[224:227]
 s_waitcnt vmcnt(15)
 ds_read_b64_tr_b16 a[96:97], v73 offset:24576
 ds_read_b64_tr_b16 a[98:99], v73 offset:25600
 v_mfma_f32_16x16x32_bf16 v[240:243], a[224:227], a[124:127], v[240:243]
 ds_read_b64_tr_b16 a[100:101], v74 offset:24576
 ds_read_b64_tr_b16 a[102:103], v74 offset:25600
 v_mfma_f32_16x16x32_bf16 v[196:199], a[228:231], a[112:115], v[196:199]
 buffer_load_dwordx4 v61, s[52:55], s10 offen offset:1024 lds
 s_waitcnt vmcnt(12)
 s_barrier
 ds_read_b64_tr_b16 a[240:241], v25 offset:0
 v_mfma_f32_16x16x32_bf16 v[212:215], a[228:231], a[116:119], v[212:215]
 ds_read_b64_tr_b16 a[242:243], v25 offset:512
 s_add_u32 m0, s81, 81920
 s_add_u32 s83, s83, 114688
 v_mfma_f32_16x16x32_bf16 v[228:231], a[228:231], a[120:123], v[228:231]
 s_waitcnt vmcnt(10)
 ds_read_b64_tr_b16 a[104:105], v69 offset:49152
 ds_read_b64_tr_b16 a[106:107], v69 offset:50176
 v_mfma_f32_16x16x32_bf16 v[244:247], a[228:231], a[124:127], v[244:247]
 ds_read_b64_tr_b16 a[108:109], v70 offset:49152
 ds_read_b64_tr_b16 a[110:111], v70 offset:50176
 s_waitcnt lgkmcnt(10)
 v_mfma_f32_16x16x32_bf16 v[200:203], a[232:235], a[112:115], v[200:203]
 ds_read_b64_tr_b16 a[244:245], v26 offset:0
 s_cmp_eq_u32 s83, 1605760
 s_cselect_b32 s83, 128, s83
 v_mfma_f32_16x16x32_bf16 v[216:219], a[232:235], a[116:119], v[216:219]
 buffer_load_dwordx4 v4, s[36:39], s83 offen offset:0 lds
 ds_read_b64_tr_b16 a[246:247], v26 offset:512
 v_mfma_f32_16x16x32_bf16 v[232:235], a[232:235], a[120:123], v[232:235]
 v_mfma_f32_16x16x32_bf16 v[248:251], a[232:235], a[124:127], v[248:251]
 v_mfma_f32_16x16x32_bf16 v[204:207], a[236:239], a[112:115], v[204:207]
 ds_read_b64_tr_b16 a[248:249], v25 offset:1024
 v_mfma_f32_16x16x32_bf16 v[220:223], a[236:239], a[116:119], v[220:223]
 buffer_load_dwordx4 v4, s[40:43], s83 offen offset:1024 lds
 ds_read_b64_tr_b16 a[250:251], v25 offset:1536
 v_mfma_f32_16x16x32_bf16 v[236:239], a[236:239], a[120:123], v[236:239]
 v_mfma_f32_16x16x32_bf16 v[252:255], a[236:239], a[124:127], v[252:255]
 s_waitcnt lgkmcnt(2)
 v_mfma_f32_16x16x32_bf16 v[192:195], a[240:243], a[128:131], v[192:195]
 ds_read_b64_tr_b16 a[252:253], v26 offset:1024
 s_add_u32 m0, s81, 24576
 s_add_u32 s83, s83, 114688
 v_mfma_f32_16x16x32_bf16 v[208:211], a[240:243], a[132:135], v[208:211]
 buffer_load_dwordx4 v4, s[36:39], s83 offen offset:0 lds
 ds_read_b64_tr_b16 a[254:255], v26 offset:1536
 v_mfma_f32_16x16x32_bf16 v[224:227], a[240:243], a[136:139], v[224:227]
 v_mfma_f32_16x16x32_bf16 v[240:243], a[240:243], a[140:143], v[240:243]
 v_mfma_f32_16x16x32_bf16 v[196:199], a[244:247], a[128:131], v[196:199]
 ds_read_b64_tr_b16 a[224:225], v25 offset:49152
 v_mfma_f32_16x16x32_bf16 v[212:215], a[244:247], a[132:135], v[212:215]
 buffer_load_dwordx4 v4, s[40:43], s83 offen offset:1024 lds
 ds_read_b64_tr_b16 a[226:227], v25 offset:49664
 v_mfma_f32_16x16x32_bf16 v[228:231], a[244:247], a[136:139], v[228:231]
 v_mfma_f32_16x16x32_bf16 v[244:247], a[244:247], a[140:143], v[244:247]
 buffer_load_dword v68, v78, s[44:47], 0 offen sc1
 s_waitcnt lgkmcnt(2)
 v_mfma_f32_16x16x32_bf16 v[200:203], a[248:251], a[128:131], v[200:203]
 ds_read_b64_tr_b16 a[228:229], v26 offset:49152
 v_mfma_f32_16x16x32_bf16 v[216:219], a[248:251], a[132:135], v[216:219]
 ds_read_b64_tr_b16 a[230:231], v26 offset:49664
 v_mfma_f32_16x16x32_bf16 v[232:235], a[248:251], a[136:139], v[232:235]
 s_add_u32 m0, s81, 73728
 s_mov_b32 s10, 752640
 v_mfma_f32_16x16x32_bf16 v[248:251], a[248:251], a[140:143], v[248:251]
 buffer_load_dwordx4 v60, s[52:55], s10 offen offset:0 lds
 v_mfma_f32_16x16x32_bf16 v[204:207], a[252:255], a[128:131], v[204:207]
 ds_read_b64_tr_b16 a[232:233], v25 offset:50176
 v_mfma_f32_16x16x32_bf16 v[220:223], a[252:255], a[132:135], v[220:223]
 ds_read_b64_tr_b16 a[234:235], v25 offset:50688
 v_mfma_f32_16x16x32_bf16 v[236:239], a[252:255], a[136:139], v[236:239]
 v_mfma_f32_16x16x32_bf16 v[252:255], a[252:255], a[140:143], v[252:255]
 buffer_load_dwordx4 v61, s[52:55], s10 offen offset:1024 lds
 s_waitcnt lgkmcnt(2)
 v_mfma_f32_16x16x32_bf16 v[192:195], a[224:227], a[144:147], v[192:195]
 ds_read_b64_tr_b16 a[236:237], v26 offset:50176
 v_mfma_f32_16x16x32_bf16 v[208:211], a[224:227], a[148:151], v[208:211]
 ds_read_b64_tr_b16 a[238:239], v26 offset:50688
 v_mfma_f32_16x16x32_bf16 v[224:227], a[224:227], a[152:155], v[224:227]
 s_add_u32 m0, s81, 131072
 s_mov_b32 s10, 974848
 v_mfma_f32_16x16x32_bf16 v[240:243], a[224:227], a[156:159], v[240:243]
 buffer_load_dwordx4 v60, s[52:55], s10 offen offset:0 lds
 v_mfma_f32_16x16x32_bf16 v[196:199], a[228:231], a[144:147], v[196:199]
 s_waitcnt vmcnt(12)
 s_barrier
 ds_read_b64_tr_b16 a[240:241], v25 offset:57344
 v_mfma_f32_16x16x32_bf16 v[212:215], a[228:231], a[148:151], v[212:215]
 ds_read_b64_tr_b16 a[242:243], v25 offset:57856
 v_mfma_f32_16x16x32_bf16 v[228:231], a[228:231], a[152:155], v[228:231]
 buffer_load_dwordx4 v61, s[52:55], s10 offen offset:1024 lds
 v_mfma_f32_16x16x32_bf16 v[244:247], a[228:231], a[156:159], v[244:247]
 s_waitcnt lgkmcnt(2)
 v_mfma_f32_16x16x32_bf16 v[200:203], a[232:235], a[144:147], v[200:203]
 ds_read_b64_tr_b16 a[244:245], v26 offset:57344
 v_mfma_f32_16x16x32_bf16 v[216:219], a[232:235], a[148:151], v[216:219]
 ds_read_b64_tr_b16 a[246:247], v26 offset:57856
 s_add_u32 m0, s81, 139264
 s_mov_b32 s10, 982016
 v_mfma_f32_16x16x32_bf16 v[232:235], a[232:235], a[152:155], v[232:235]
 buffer_load_dwordx4 v60, s[52:55], s10 offen offset:0 lds
 v_mfma_f32_16x16x32_bf16 v[248:251], a[232:235], a[156:159], v[248:251]
 v_mfma_f32_16x16x32_bf16 v[204:207], a[236:239], a[144:147], v[204:207]
 ds_read_b64_tr_b16 a[248:249], v25 offset:58368
 v_mfma_f32_16x16x32_bf16 v[220:223], a[236:239], a[148:151], v[220:223]
 ds_read_b64_tr_b16 a[250:251], v25 offset:58880
 v_mfma_f32_16x16x32_bf16 v[236:239], a[236:239], a[152:155], v[236:239]
 buffer_load_dwordx4 v61, s[52:55], s10 offen offset:1024 lds
 v_mfma_f32_16x16x32_bf16 v[252:255], a[236:239], a[156:159], v[252:255]
 s_waitcnt lgkmcnt(2)
 v_mfma_f32_16x16x32_bf16 v[192:195], a[240:243], a[160:163], v[192:195]
 ds_read_b64_tr_b16 a[252:253], v26 offset:58368
 v_mfma_f32_16x16x32_bf16 v[208:211], a[240:243], a[164:167], v[208:211]
 ds_read_b64_tr_b16 a[254:255], v26 offset:58880
 s_add_u32 m0, s81, 0
 s_mov_b32 s10, 1204224
 v_mfma_f32_16x16x32_bf16 v[224:227], a[240:243], a[168:171], v[224:227]
 buffer_load_dwordx4 v60, s[52:55], s10 offen offset:0 lds
 v_mfma_f32_16x16x32_bf16 v[240:243], a[240:243], a[172:175], v[240:243]
 v_mfma_f32_16x16x32_bf16 v[196:199], a[244:247], a[160:163], v[196:199]
 ds_read_b64_tr_b16 a[224:225], v29 offset:16384
 v_mfma_f32_16x16x32_bf16 v[212:215], a[244:247], a[164:167], v[212:215]
 ds_read_b64_tr_b16 a[226:227], v29 offset:16896
 v_mfma_f32_16x16x32_bf16 v[228:231], a[244:247], a[168:171], v[228:231]
 buffer_load_dwordx4 v61, s[52:55], s10 offen offset:1024 lds
 v_mfma_f32_16x16x32_bf16 v[244:247], a[244:247], a[172:175], v[244:247]
 s_waitcnt vmcnt(8)
 v_cmp_lt_u32 vcc, 1, v68
 s_nop 0
 s_cmp_eq_u64 vcc, -1
 s_cbranch_scc0 L_spin_A
L_ok_A:
 s_waitcnt lgkmcnt(2)
 v_mfma_f32_16x16x32_bf16 v[200:203], a[248:251], a[160:163], v[200:203]
 ds_read_b64_tr_b16 a[228:229], v30 offset:16384
 s_mov_b32 s26, 0
 v_mfma_f32_16x16x32_bf16 v[216:219], a[248:251], a[164:167], v[216:219]
 buffer_load_dwordx4 a[112:115], v62, s[44:47], s26 offen offset:0 sc1
 ds_read_b64_tr_b16 a[230:231], v30 offset:16896
 v_mfma_f32_16x16x32_bf16 v[232:235], a[248:251], a[168:171], v[232:235]
 v_mfma_f32_16x16x32_bf16 v[248:251], a[248:251], a[172:175], v[248:251]
 v_mfma_f32_16x16x32_bf16 v[204:207], a[252:255], a[160:163], v[204:207]
 ds_read_b64_tr_b16 a[232:233], v29 offset:17408
 v_mfma_f32_16x16x32_bf16 v[220:223], a[252:255], a[164:167], v[220:223]
 buffer_load_dwordx4 a[116:119], v63, s[44:47], s26 offen offset:0 sc1
 ds_read_b64_tr_b16 a[234:235], v29 offset:17920
 v_mfma_f32_16x16x32_bf16 v[236:239], a[252:255], a[168:171], v[236:239]
 v_mfma_f32_16x16x32_bf16 v[252:255], a[252:255], a[172:175], v[252:255]
 s_waitcnt lgkmcnt(2)
 v_mfma_f32_16x16x32_bf16 v[192:195], a[224:227], a[176:179], v[192:195]
 ds_read_b64_tr_b16 a[236:237], v30 offset:17408
 v_mfma_f32_16x16x32_bf16 v[208:211], a[224:227], a[180:183], v[208:211]
 buffer_load_dwordx4 a[120:123], v62, s[44:47], s26 offen offset:2048 sc1
 ds_read_b64_tr_b16 a[238:239], v30 offset:17920
 v_mfma_f32_16x16x32_bf16 v[224:227], a[224:227], a[184:187], v[224:227]
 s_barrier
 ds_read_b64_tr_b16 a[240:241], v25 offset:16384
 v_mfma_f32_16x16x32_bf16 v[240:243], a[224:227], a[188:191], v[240:243]
 ds_read_b64_tr_b16 a[242:243], v25 offset:16896
 v_mfma_f32_16x16x32_bf16 v[196:199], a[228:231], a[176:179], v[196:199]
 buffer_load_dwordx4 a[124:127], v63, s[44:47], s26 offen offset:2048 sc1
 ds_read_b64_tr_b16 a[244:245], v26 offset:16384
 v_mfma_f32_16x16x32_bf16 v[212:215], a[228:231], a[180:183], v[212:215]
 ds_read_b64_tr_b16 a[246:247], v26 offset:16896
 v_mfma_f32_16x16x32_bf16 v[228:231], a[228:231], a[184:187], v[228:231]
 ds_read_b64_tr_b16 a[248:249], v25 offset:17408
 v_mfma_f32_16x16x32_bf16 v[244:247], a[228:231], a[188:191], v[244:247]
 ds_read_b64_tr_b16 a[250:251], v25 offset:17920
 s_mov_b32 s26, 4096
 s_waitcnt lgkmcnt(6)
 v_mfma_f32_16x16x32_bf16 v[200:203], a[232:235], a[176:179], v[200:203]
 buffer_load_dwordx4 a[128:131], v62, s[44:47], s26 offen offset:0 sc1
 ds_read_b64_tr_b16 a[252:253], v26 offset:17408
 v_mfma_f32_16x16x32_bf16 v[216:219], a[232:235], a[180:183], v[216:219]
 ds_read_b64_tr_b16 a[254:255], v26 offset:17920
 v_mfma_f32_16x16x32_bf16 v[232:235], a[232:235], a[184:187], v[232:235]
 ds_read_b64_tr_b16 a[224:225], v21 offset:24576
 v_mfma_f32_16x16x32_bf16 v[248:251], a[232:235], a[188:191], v[248:251]
 ds_read_b64_tr_b16 a[226:227], v21 offset:25088
 v_mfma_f32_16x16x32_bf16 v[204:207], a[236:239], a[176:179], v[204:207]
 buffer_load_dwordx4 a[132:135], v63, s[44:47], s26 offen offset:0 sc1
 ds_read_b64_tr_b16 a[228:229], v22 offset:24576
 v_mfma_f32_16x16x32_bf16 v[220:223], a[236:239], a[180:183], v[220:223]
 ds_read_b64_tr_b16 a[230:231], v22 offset:25088
 v_mfma_f32_16x16x32_bf16 v[236:239], a[236:239], a[184:187], v[236:239]
 ds_read_b64_tr_b16 a[232:233], v21 offset:25600
 v_mfma_f32_16x16x32_bf16 v[252:255], a[236:239], a[188:191], v[252:255]
 ds_read_b64_tr_b16 a[234:235], v21 offset:26112
 s_waitcnt lgkmcnt(12)
 v_mfma_f32_16x16x32_bf16 v[192:195], a[240:243], a[192:195], v[192:195]
 buffer_load_dwordx4 a[136:139], v62, s[44:47], s26 offen offset:2048 sc1
 ds_read_b64_tr_b16 a[236:237], v22 offset:25600
 ds_read_b64_tr_b16 a[238:239], v22 offset:26112
 s_waitcnt lgkmcnt(12)
 v_mfma_f32_16x16x32_bf16 v[196:199], a[244:247], a[192:195], v[196:199]
 s_waitcnt lgkmcnt(10)
 v_mfma_f32_16x16x32_bf16 v[200:203], a[248:251], a[192:195], v[200:203]
 s_waitcnt lgkmcnt(8)
 v_mfma_f32_16x16x32_bf16 v[204:207], a[252:255], a[192:195], v[204:207]
 s_waitcnt lgkmcnt(6)
 v_mfma_f32_16x16x32_bf16 v[192:195], a[224:227], a[208:211], v[192:195]
 buffer_load_dwordx4 a[140:143], v63, s[44:47], s26 offen offset:2048 sc1
 s_waitcnt lgkmcnt(4)
 v_mfma_f32_16x16x32_bf16 v[196:199], a[228:231], a[208:211], v[196:199]
 s_waitcnt lgkmcnt(2)
 v_mfma_f32_16x16x32_bf16 v[200:203], a[232:235], a[208:211], v[200:203]
 s_waitcnt lgkmcnt(0)
 v_mfma_f32_16x16x32_bf16 v[204:207], a[236:239], a[208:211], v[204:207]
 s_mov_b32 s26, 8192
 v_mfma_f32_16x16x32_bf16 v[208:211], a[240:243], a[196:199], v[208:211]
 buffer_load_dwordx4 a[144:147], v62, s[44:47], s26 offen offset:0 sc1
 v_mfma_f32_16x16x32_bf16 v[212:215], a[244:247], a[196:199], v[212:215]
 v_mfma_f32_16x16x32_bf16 v[216:219], a[248:251], a[196:199], v[216:219]
 v_max_f32 v192, 0, v192
 v_max_f32 v193, 0, v193
 v_max_f32 v194, 0, v194
 v_max_f32 v195, 0, v195
 v_mfma_f32_16x16x32_bf16 v[220:223], a[252:255], a[196:199], v[220:223]
 v_max_f32 v196, 0, v196
 v_max_f32 v197, 0, v197
 v_max_f32 v198, 0, v198
 v_max_f32 v199, 0, v199
 v_mfma_f32_16x16x32_bf16 v[208:211], a[224:227], a[212:215], v[208:211]
 buffer_load_dwordx4 a[148:151], v63, s[44:47], s26 offen offset:0 sc1
 v_mul_f32 v192, v192, v200
 v_mul_f32 v193, v193, v201
 v_mul_f32 v194, v194, v202
 v_mfma_f32_16x16x32_bf16 v[212:215], a[228:231], a[212:215], v[212:215]
 v_mul_f32 v195, v195, v203
 v_mul_f32 v196, v196, v204
 v_mul_f32 v197, v197, v205
 v_mul_f32 v198, v198, v206
 v_mfma_f32_16x16x32_bf16 v[216:219], a[232:235], a[212:215], v[216:219]
 v_mul_f32 v199, v199, v207
 v_cvt_pk_bf16_f32 v200, v192, v193
 v_cvt_pk_bf16_f32 v201, v194, v195
 v_cvt_pk_bf16_f32 v202, v196, v197
 v_mfma_f32_16x16x32_bf16 v[220:223], a[236:239], a[212:215], v[220:223]
 buffer_load_dwordx4 a[152:155], v62, s[44:47], s26 offen offset:2048 sc1
 v_cvt_pk_bf16_f32 v203, v198, v199
 s_movk_i32 s88, 28672
 v_mfma_f32_16x16x32_bf16 v[224:227], a[240:243], a[200:203], v[224:227]
 v_mfma_f32_16x16x32_bf16 v[228:231], a[244:247], a[200:203], v[228:231]
 buffer_store_dwordx4 v[200:203], v8, s[44:47], s88 offen offset:0 sc1
 v_mfma_f32_16x16x32_bf16 v[232:235], a[248:251], a[200:203], v[232:235]
 v_max_f32 v208, 0, v208
 v_max_f32 v209, 0, v209
 v_max_f32 v210, 0, v210
 v_max_f32 v211, 0, v211
 v_mfma_f32_16x16x32_bf16 v[236:239], a[252:255], a[200:203], v[236:239]
 v_max_f32 v212, 0, v212
 v_max_f32 v213, 0, v213
 v_max_f32 v214, 0, v214
 v_max_f32 v215, 0, v215
 v_mfma_f32_16x16x32_bf16 v[224:227], a[224:227], a[216:219], v[224:227]
 buffer_load_dwordx4 a[156:159], v63, s[44:47], s26 offen offset:2048 sc1
 v_mul_f32 v208, v208, v216
 v_mul_f32 v209, v209, v217
 v_mul_f32 v210, v210, v218
 v_mfma_f32_16x16x32_bf16 v[228:231], a[228:231], a[216:219], v[228:231]
 v_mul_f32 v211, v211, v219
 v_mul_f32 v212, v212, v220
 v_mul_f32 v213, v213, v221
 v_mul_f32 v214, v214, v222
 v_mfma_f32_16x16x32_bf16 v[232:235], a[232:235], a[216:219], v[232:235]
 s_mov_b32 s26, 12288
 v_mul_f32 v215, v215, v223
 v_cvt_pk_bf16_f32 v216, v208, v209
 v_cvt_pk_bf16_f32 v217, v210, v211
 v_mfma_f32_16x16x32_bf16 v[236:239], a[236:239], a[216:219], v[236:239]
 buffer_load_dwordx4 a[160:163], v62, s[44:47], s26 offen offset:0 sc1
 v_cvt_pk_bf16_f32 v218, v212, v213
 v_cvt_pk_bf16_f32 v219, v214, v215
 v_mfma_f32_16x16x32_bf16 v[240:243], a[240:243], a[204:207], v[240:243]
 v_mfma_f32_16x16x32_bf16 v[244:247], a[244:247], a[204:207], v[244:247]
 buffer_store_dwordx4 v[216:219], v8, s[44:47], s88 offen offset:256 sc1
 v_mfma_f32_16x16x32_bf16 v[248:251], a[248:251], a[204:207], v[248:251]
 v_max_f32 v224, 0, v224
 v_max_f32 v225, 0, v225
 v_max_f32 v226, 0, v226
 v_max_f32 v227, 0, v227
 v_mfma_f32_16x16x32_bf16 v[252:255], a[252:255], a[204:207], v[252:255]
 v_max_f32 v228, 0, v228
 v_max_f32 v229, 0, v229
 v_max_f32 v230, 0, v230
 v_max_f32 v231, 0, v231
 v_mfma_f32_16x16x32_bf16 v[240:243], a[224:227], a[220:223], v[240:243]
 buffer_load_dwordx4 a[164:167], v63, s[44:47], s26 offen offset:0 sc1
 v_mul_f32 v224, v224, v232
 v_mul_f32 v225, v225, v233
 v_mul_f32 v226, v226, v234
 v_mfma_f32_16x16x32_bf16 v[244:247], a[228:231], a[220:223], v[244:247]
 v_mul_f32 v227, v227, v235
 v_mul_f32 v228, v228, v236
 v_mul_f32 v229, v229, v237
 v_mul_f32 v230, v230, v238
 v_mfma_f32_16x16x32_bf16 v[248:251], a[232:235], a[220:223], v[248:251]
 v_mul_f32 v231, v231, v239
 v_cvt_pk_bf16_f32 v232, v224, v225
 v_cvt_pk_bf16_f32 v233, v226, v227
 v_cvt_pk_bf16_f32 v234, v228, v229
 v_mfma_f32_16x16x32_bf16 v[252:255], a[236:239], a[220:223], v[252:255]
 buffer_load_dwordx4 a[168:171], v62, s[44:47], s26 offen offset:2048 sc1
 v_cvt_pk_bf16_f32 v235, v230, v231
 s_barrier
 buffer_store_dwordx4 v[232:235], v8, s[44:47], s88 offen offset:1024 sc1
 v_max_f32 v240, 0, v240
 v_max_f32 v241, 0, v241
 v_max_f32 v242, 0, v242
 v_max_f32 v243, 0, v243
 v_max_f32 v244, 0, v244
 v_max_f32 v245, 0, v245
 v_max_f32 v246, 0, v246
 v_max_f32 v247, 0, v247
 v_mul_f32 v240, v240, v248
 v_mul_f32 v241, v241, v249
 v_mul_f32 v242, v242, v250
 v_mul_f32 v243, v243, v251
 v_mul_f32 v244, v244, v252
 v_mul_f32 v245, v245, v253
 v_mul_f32 v246, v246, v254
 v_mul_f32 v247, v247, v255
 v_cvt_pk_bf16_f32 v248, v240, v241
 v_cvt_pk_bf16_f32 v249, v242, v243
 v_cvt_pk_bf16_f32 v250, v244, v245
 v_cvt_pk_bf16_f32 v251, v246, v247
 buffer_store_dwordx4 v[248:251], v8, s[44:47], s88 offen offset:1280 sc1
 s_waitcnt vmcnt(17)
 v_mfma_f32_32x32x16_bf16 v[160:175], v[96:99], a[116:119], 0
 buffer_load_dwordx4 a[172:175], v63, s[44:47], s26 offen offset:2048 sc1
 v_mfma_f32_32x32x16_bf16 v[176:191], v[100:103], a[116:119], 0
 s_mov_b32 s26, 16384
 buffer_load_dwordx4 a[176:179], v62, s[44:47], s26 offen offset:0 sc1
 v_mfma_f32_32x32x16_bf16 v[144:159], v[100:103], a[112:115], 0
 buffer_load_dwordx4 a[180:183], v63, s[44:47], s26 offen offset:0 sc1
 v_mfma_f32_32x32x16_bf16 v[128:143], v[96:99], a[112:115], 0
 s_waitcnt vmcnt(18)
 v_mfma_f32_32x32x16_bf16 v[160:175], v[104:107], a[124:127], v[160:175]
 buffer_load_dwordx4 a[184:187], v62, s[44:47], s26 offen offset:2048 sc1
 v_mfma_f32_32x32x16_bf16 v[176:191], v[108:111], a[124:127], v[176:191]
 buffer_load_dwordx4 a[188:191], v63, s[44:47], s26 offen offset:2048 sc1
 v_mfma_f32_32x32x16_bf16 v[144:159], v[108:111], a[120:123], v[144:159]
 s_mov_b32 s26, 20480
 buffer_load_dwordx4 a[192:195], v62, s[44:47], s26 offen offset:0 sc1
 v_mfma_f32_32x32x16_bf16 v[128:143], v[104:107], a[120:123], v[128:143]
 s_waitcnt vmcnt(6)
 s_barrier
 s_cmp_eq_u32 s72, 0
 s_cbranch_scc0 L_sigB
 buffer_store_dword v12, v33, s[44:47], s27 offen sc1
L_sigB:
 v_mfma_f32_32x32x16_bf16 v[160:175], v[112:115], a[132:135], v[160:175]
 buffer_load_dwordx4 a[196:199], v63, s[44:47], s26 offen offset:0 sc1
 v_mfma_f32_32x32x16_bf16 v[176:191], v[116:119], a[132:135], v[176:191]
 buffer_load_dwordx4 a[200:203], v62, s[44:47], s26 offen offset:2048 sc1
 v_mfma_f32_32x32x16_bf16 v[144:159], v[116:119], a[128:131], v[144:159]
 buffer_load_dwordx4 a[204:207], v63, s[44:47], s26 offen offset:2048 sc1
 v_mfma_f32_32x32x16_bf16 v[128:143], v[112:115], a[128:131], v[128:143]
 v_mfma_f32_32x32x16_bf16 v[160:175], v[120:123], a[140:143], v[160:175]
 s_mov_b32 s26, 24576
 buffer_load_dwordx4 a[208:211], v62, s[44:47], s26 offen offset:0 sc1
 v_mfma_f32_32x32x16_bf16 v[176:191], v[124:127], a[140:143], v[176:191]
 buffer_load_dwordx4 a[212:215], v63, s[44:47], s26 offen offset:0 sc1
 v_mfma_f32_32x32x16_bf16 v[144:159], v[124:127], a[136:139], v[144:159]
 buffer_load_dwordx4 a[216:219], v62, s[44:47], s26 offen offset:2048 sc1
 v_mfma_f32_32x32x16_bf16 v[128:143], v[120:123], a[136:139], v[128:143]
 v_mfma_f32_32x32x16_bf16 v[160:175], a[0:3], a[148:151], v[160:175]
 buffer_load_dwordx4 a[220:223], v63, s[44:47], s26 offen offset:2048 sc1
 v_mfma_f32_32x32x16_bf16 v[176:191], a[4:7], a[148:151], v[176:191]
 s_add_u32 m0, s81, 16384
 s_mov_b32 s10, 1211392
 buffer_load_dwordx4 v60, s[52:55], s10 offen offset:0 lds
 v_mfma_f32_32x32x16_bf16 v[144:159], a[4:7], a[144:147], v[144:159]
 buffer_load_dwordx4 v61, s[52:55], s10 offen offset:1024 lds
 v_mfma_f32_32x32x16_bf16 v[128:143], a[0:3], a[144:147], v[128:143]
 v_mfma_f32_32x32x16_bf16 v[160:175], a[8:11], a[156:159], v[160:175]
 s_add_u32 m0, s81, 90112
 s_mov_b32 s10, 1433600
 buffer_load_dwordx4 v60, s[52:55], s10 offen offset:0 lds
 v_mfma_f32_32x32x16_bf16 v[176:191], a[12:15], a[156:159], v[176:191]
 buffer_load_dwordx4 v61, s[52:55], s10 offen offset:1024 lds
 v_mfma_f32_32x32x16_bf16 v[144:159], a[12:15], a[152:155], v[144:159]
 s_add_u32 m0, s81, 155648
 s_mov_b32 s10, 1440768
 buffer_load_dwordx4 v60, s[52:55], s10 offen offset:0 lds
 v_mfma_f32_32x32x16_bf16 v[128:143], a[8:11], a[152:155], v[128:143]
 v_mfma_f32_32x32x16_bf16 v[160:175], a[16:19], a[164:167], v[160:175]
 buffer_load_dwordx4 v61, s[52:55], s10 offen offset:1024 lds
 v_mfma_f32_32x32x16_bf16 v[176:191], a[20:23], a[164:167], v[176:191]
 v_add_u32 v60, s11, v60
 v_add_u32 v61, 6144, v60
 s_add_u32 m0, s81, 49152
 s_mov_b32 s10, 0
 buffer_load_dwordx4 v60, s[56:59], s10 offen offset:0 lds
 v_mfma_f32_32x32x16_bf16 v[144:159], a[20:23], a[160:163], v[144:159]
 buffer_load_dwordx4 v61, s[56:59], s10 offen offset:1024 lds
 v_mfma_f32_32x32x16_bf16 v[128:143], a[16:19], a[160:163], v[128:143]
 s_waitcnt vmcnt(20)
 v_mfma_f32_32x32x16_bf16 v[160:175], a[24:27], a[172:175], v[160:175]
 s_add_u32 m0, s81, 98304
 s_mov_b32 s10, 14336
 buffer_load_dwordx4 v60, s[56:59], s10 offen offset:0 lds
 v_mfma_f32_32x32x16_bf16 v[176:191], a[28:31], a[172:175], v[176:191]
 buffer_load_dwordx4 v61, s[56:59], s10 offen offset:1024 lds
 v_mfma_f32_32x32x16_bf16 v[144:159], a[28:31], a[168:171], v[144:159]
 s_add_u32 m0, s81, 32768
 s_mov_b32 s10, 28672
 buffer_load_dwordx4 v60, s[56:59], s10 offen offset:0 lds
 v_mfma_f32_32x32x16_bf16 v[128:143], a[24:27], a[168:171], v[128:143]
 buffer_load_dword v68, v78, s[44:47], 0 offen sc1
 s_waitcnt vmcnt(22)
 v_mfma_f32_32x32x16_bf16 v[160:175], a[32:35], a[180:183], v[160:175]
 buffer_load_dwordx4 v61, s[56:59], s10 offen offset:1024 lds
 v_mfma_f32_32x32x16_bf16 v[176:191], a[36:39], a[180:183], v[176:191]
 s_add_u32 m0, s81, 40960
 s_mov_b32 s10, 43008
 buffer_load_dwordx4 v60, s[56:59], s10 offen offset:0 lds
 v_mfma_f32_32x32x16_bf16 v[144:159], a[36:39], a[176:179], v[144:159]
 buffer_load_dwordx4 v61, s[56:59], s10 offen offset:1024 lds
 v_mfma_f32_32x32x16_bf16 v[128:143], a[32:35], a[176:179], v[128:143]
 s_waitcnt vmcnt(23)
 v_mfma_f32_32x32x16_bf16 v[160:175], a[40:43], a[188:191], v[160:175]
 s_add_u32 m0, s81, 65536
 s_mov_b32 s10, 57344
 buffer_load_dwordx4 v60, s[56:59], s10 offen offset:0 lds
 v_mfma_f32_32x32x16_bf16 v[176:191], a[44:47], a[188:191], v[176:191]
 buffer_load_dwordx4 v61, s[56:59], s10 offen offset:1024 lds
 v_mfma_f32_32x32x16_bf16 v[144:159], a[44:47], a[184:187], v[144:159]
 s_add_u32 m0, s81, 114688
 s_mov_b32 s10, 71680
 buffer_load_dwordx4 v60, s[56:59], s10 offen offset:0 lds
 v_mfma_f32_32x32x16_bf16 v[128:143], a[40:43], a[184:187], v[128:143]
 s_waitcnt vmcnt(24)
 v_mfma_f32_32x32x16_bf16 v[160:175], a[48:51], a[196:199], v[160:175]
 buffer_load_dwordx4 v61, s[56:59], s10 offen offset:1024 lds
 v_mfma_f32_32x32x16_bf16 v[176:191], a[52:55], a[196:199], v[176:191]
 s_add_u32 m0, s81, 122880
 s_mov_b32 s10, 86016
 buffer_load_dwordx4 v60, s[56:59], s10 offen offset:0 lds
 v_mfma_f32_32x32x16_bf16 v[144:159], a[52:55], a[192:195], v[144:159]
 buffer_load_dwordx4 v61, s[56:59], s10 offen offset:1024 lds
 v_mfma_f32_32x32x16_bf16 v[128:143], a[48:51], a[192:195], v[128:143]
 s_waitcnt vmcnt(25)
 v_mfma_f32_32x32x16_bf16 v[160:175], a[56:59], a[204:207], v[160:175]
 v_mfma_f32_32x32x16_bf16 v[176:191], a[60:63], a[204:207], v[176:191]
 v_mfma_f32_32x32x16_bf16 v[144:159], a[60:63], a[200:203], v[144:159]
 v_mfma_f32_32x32x16_bf16 v[128:143], a[56:59], a[200:203], v[128:143]
 s_waitcnt vmcnt(9)
 v_cmp_lt_u32 vcc, 2, v68
 s_nop 0
 s_cmp_eq_u64 vcc, -1
 s_cbranch_scc0 L_spin_B
L_ok_B:
 s_mov_b32 s26, 28672
 buffer_load_dwordx4 a[0:3], v62, s[44:47], s26 offen offset:0 sc1
 buffer_load_dwordx4 a[4:7], v63, s[44:47], s26 offen offset:0 sc1
 buffer_load_dwordx4 a[8:11], v62, s[44:47], s26 offen offset:2048 sc1
 buffer_load_dwordx4 a[12:15], v63, s[44:47], s26 offen offset:2048 sc1
 s_mov_b32 s26, 32768
 buffer_load_dwordx4 a[16:19], v62, s[44:47], s26 offen offset:0 sc1
 buffer_load_dwordx4 a[20:23], v63, s[44:47], s26 offen offset:0 sc1
 buffer_load_dwordx4 a[24:27], v62, s[44:47], s26 offen offset:2048 sc1
 buffer_load_dwordx4 a[28:31], v63, s[44:47], s26 offen offset:2048 sc1
 v_mfma_f32_32x32x16_bf16 v[160:175], a[64:67], a[212:215], v[160:175]
 v_mfma_f32_32x32x16_bf16 v[176:191], a[68:71], a[212:215], v[176:191]
 v_mfma_f32_32x32x16_bf16 v[144:159], a[68:71], a[208:211], v[144:159]
 v_mfma_f32_32x32x16_bf16 v[128:143], a[64:67], a[208:211], v[128:143]
 v_mfma_f32_32x32x16_bf16 v[160:175], a[72:75], a[220:223], v[160:175]
 s_mov_b32 s26, 36864
 buffer_load_dwordx4 a[32:35], v62, s[44:47], s26 offen offset:0 sc1
 v_mfma_f32_32x32x16_bf16 v[176:191], a[76:79], a[220:223], v[176:191]
 buffer_load_dwordx4 a[36:39], v63, s[44:47], s26 offen offset:0 sc1
 v_mfma_f32_32x32x16_bf16 v[144:159], a[76:79], a[216:219], v[144:159]
 v_mfma_f32_32x32x16_bf16 v[128:143], a[72:75], a[216:219], v[128:143]
 s_waitcnt vmcnt(8)
 v_mfma_f32_32x32x16_bf16 v[160:175], a[80:83], a[4:7], v[160:175]
 buffer_load_dwordx4 a[40:43], v62, s[44:47], s26 offen offset:2048 sc1
 v_mfma_f32_32x32x16_bf16 v[176:191], a[84:87], a[4:7], v[176:191]
 buffer_load_dwordx4 a[44:47], v63, s[44:47], s26 offen offset:2048 sc1
 v_mfma_f32_32x32x16_bf16 v[144:159], a[84:87], a[0:3], v[144:159]
 v_mfma_f32_32x32x16_bf16 v[128:143], a[80:83], a[0:3], v[128:143]
 s_waitcnt vmcnt(8)
 v_mfma_f32_32x32x16_bf16 v[160:175], a[88:91], a[12:15], v[160:175]
 s_mov_b32 s26, 40960
 buffer_load_dwordx4 a[48:51], v62, s[44:47], s26 offen offset:0 sc1
 v_mfma_f32_32x32x16_bf16 v[176:191], a[92:95], a[12:15], v[176:191]
 buffer_load_dwordx4 a[52:55], v63, s[44:47], s26 offen offset:0 sc1
 v_mfma_f32_32x32x16_bf16 v[144:159], a[92:95], a[8:11], v[144:159]
 v_mfma_f32_32x32x16_bf16 v[128:143], a[88:91], a[8:11], v[128:143]
 s_waitcnt vmcnt(8)
 v_mfma_f32_32x32x16_bf16 v[160:175], a[96:99], a[20:23], v[160:175]
 buffer_load_dwordx4 a[56:59], v62, s[44:47], s26 offen offset:2048 sc1
 v_mfma_f32_32x32x16_bf16 v[176:191], a[100:103], a[20:23], v[176:191]
 buffer_load_dwordx4 a[60:63], v63, s[44:47], s26 offen offset:2048 sc1
 v_mfma_f32_32x32x16_bf16 v[144:159], a[100:103], a[16:19], v[144:159]
 v_mfma_f32_32x32x16_bf16 v[128:143], a[96:99], a[16:19], v[128:143]
 s_waitcnt vmcnt(8)
 v_mfma_f32_32x32x16_bf16 v[160:175], a[104:107], a[28:31], v[160:175]
 s_mov_b32 s26, 45056
 buffer_load_dwordx4 a[64:67], v62, s[44:47], s26 offen offset:0 sc1
 ds_read_b64_tr_b16 a[240:241], v69 offset:57344
 ds_read_b64_tr_b16 a[242:243], v69 offset:58368
 ds_read_b64_tr_b16 a[244:245], v70 offset:57344
 ds_read_b64_tr_b16 a[246:247], v70 offset:58368
 v_mfma_f32_32x32x16_bf16 v[176:191], a[108:111], a[28:31], v[176:191]
 buffer_load_dwordx4 a[68:71], v63, s[44:47], s26 offen offset:0 sc1
 v_mfma_f32_32x32x16_bf16 v[144:159], a[108:111], a[24:27], v[144:159]
 v_mfma_f32_32x32x16_bf16 v[128:143], a[104:107], a[24:27], v[128:143]
 s_waitcnt vmcnt(8) lgkmcnt(0)
 v_mfma_f32_32x32x16_bf16 v[160:175], a[240:243], a[36:39], v[160:175]
 buffer_load_dwordx4 a[72:75], v62, s[44:47], s26 offen offset:2048 sc1
 ds_read_b64_tr_b16 a[248:249], v69 offset:8192
 ds_read_b64_tr_b16 a[250:251], v69 offset:9216
 ds_read_b64_tr_b16 a[252:253], v70 offset:8192
 ds_read_b64_tr_b16 a[254:255], v70 offset:9216
 v_mfma_f32_32x32x16_bf16 v[176:191], a[244:247], a[36:39], v[176:191]
 buffer_load_dwordx4 a[76:79], v63, s[44:47], s26 offen offset:2048 sc1
 v_mfma_f32_32x32x16_bf16 v[144:159], a[244:247], a[32:35], v[144:159]
 v_mfma_f32_32x32x16_bf16 v[128:143], a[240:243], a[32:35], v[128:143]
 s_waitcnt vmcnt(8) lgkmcnt(0)
 v_mfma_f32_32x32x16_bf16 v[160:175], a[248:251], a[44:47], v[160:175]
 s_mov_b32 s26, 49152
 buffer_load_dwordx4 a[80:83], v62, s[44:47], s26 offen offset:0 sc1
 ds_read_b64_tr_b16 a[224:225], v71 offset:40960
 ds_read_b64_tr_b16 a[226:227], v71 offset:41984
 ds_read_b64_tr_b16 a[228:229], v72 offset:40960
 ds_read_b64_tr_b16 a[230:231], v72 offset:41984
 v_mfma_f32_32x32x16_bf16 v[176:191], a[252:255], a[44:47], v[176:191]
 buffer_load_dwordx4 a[84:87], v63, s[44:47], s26 offen offset:0 sc1
 v_mfma_f32_32x32x16_bf16 v[144:159], a[252:255], a[40:43], v[144:159]
 v_mfma_f32_32x32x16_bf16 v[128:143], a[248:251], a[40:43], v[128:143]
 buffer_load_dword v68, v79, s[44:47], 0 offen sc1
 s_waitcnt vmcnt(9) lgkmcnt(0)
 v_mfma_f32_32x32x16_bf16 v[160:175], a[224:227], a[52:55], v[160:175]
 buffer_load_dwordx4 a[88:91], v62, s[44:47], s26 offen offset:2048 sc1
 ds_read_b64_tr_b16 a[232:233], v71 offset:8192
 ds_read_b64_tr_b16 a[234:235], v71 offset:9216
 ds_read_b64_tr_b16 a[236:237], v72 offset:8192
 ds_read_b64_tr_b16 a[238:239], v72 offset:9216
 v_mfma_f32_32x32x16_bf16 v[176:191], a[228:231], a[52:55], v[176:191]
 buffer_load_dwordx4 a[92:95], v63, s[44:47], s26 offen offset:2048 sc1
 v_mfma_f32_32x32x16_bf16 v[144:159], a[228:231], a[48:51], v[144:159]
 v_mfma_f32_32x32x16_bf16 v[128:143], a[224:227], a[48:51], v[128:143]
 s_waitcnt vmcnt(9) lgkmcnt(0)
 v_mfma_f32_32x32x16_bf16 v[160:175], a[232:235], a[60:63], v[160:175]
 s_mov_b32 s26, 53248
 buffer_load_dwordx4 a[96:99], v62, s[44:47], s26 offen offset:0 sc1
 ds_read_b64_tr_b16 a[240:241], v73 offset:0
 ds_read_b64_tr_b16 a[242:243], v73 offset:1024
 ds_read_b64_tr_b16 a[244:245], v74 offset:0
 ds_read_b64_tr_b16 a[246:247], v74 offset:1024
 v_mfma_f32_32x32x16_bf16 v[176:191], a[236:239], a[60:63], v[176:191]
 buffer_load_dwordx4 a[100:103], v63, s[44:47], s26 offen offset:0 sc1
 v_mfma_f32_32x32x16_bf16 v[144:159], a[236:239], a[56:59], v[144:159]
 v_mfma_f32_32x32x16_bf16 v[128:143], a[232:235], a[56:59], v[128:143]
 s_waitcnt vmcnt(9) lgkmcnt(0)
 v_mfma_f32_32x32x16_bf16 v[160:175], a[240:243], a[68:71], v[160:175]
 buffer_load_dwordx4 a[104:107], v62, s[44:47], s26 offen offset:2048 sc1
 ds_read_b64_tr_b16 a[248:249], v73 offset:8192
 ds_read_b64_tr_b16 a[250:251], v73 offset:9216
 ds_read_b64_tr_b16 a[252:253], v74 offset:8192
 ds_read_b64_tr_b16 a[254:255], v74 offset:9216
 v_mfma_f32_32x32x16_bf16 v[176:191], a[244:247], a[68:71], v[176:191]
 buffer_load_dwordx4 a[108:111], v63, s[44:47], s26 offen offset:2048 sc1
 v_mfma_f32_32x32x16_bf16 v[144:159], a[244:247], a[64:67], v[144:159]
 ds_read_b64_tr_b16 v[200:201], v71 offset:32768
 ds_read_b64_tr_b16 v[202:203], v71 offset:33792
 ds_read_b64_tr_b16 v[204:205], v72 offset:32768
 ds_read_b64_tr_b16 v[206:207], v72 offset:33792
 v_mfma_f32_32x32x16_bf16 v[128:143], a[240:243], a[64:67], v[128:143]
 s_waitcnt vmcnt(9) lgkmcnt(4)
 v_mfma_f32_32x32x16_bf16 v[160:175], a[248:251], a[76:79], v[160:175]
 ds_read_b64_tr_b16 a[224:225], v69 offset:0
 ds_read_b64_tr_b16 a[226:227], v69 offset:1024
 ds_read_b64_tr_b16 a[228:229], v70 offset:0
 ds_read_b64_tr_b16 a[230:231], v70 offset:1024
 v_mfma_f32_32x32x16_bf16 v[176:191], a[252:255], a[76:79], v[176:191]
 v_mfma_f32_32x32x16_bf16 v[144:159], a[252:255], a[72:75], v[144:159]
 ds_read_b64_tr_b16 v[208:209], v69 offset:32768
 ds_read_b64_tr_b16 v[210:211], v69 offset:33792
 ds_read_b64_tr_b16 v[212:213], v70 offset:32768
 ds_read_b64_tr_b16 v[214:215], v70 offset:33792
 v_mfma_f32_32x32x16_bf16 v[128:143], a[248:251], a[72:75], v[128:143]
 s_waitcnt vmcnt(6)
 v_cmp_lt_u32 vcc, 0, v68
 s_nop 0
 s_cmp_eq_u64 vcc, -1
 s_cbranch_scc0 L_spin_O
L_ok_O:
 buffer_load_dword v64, v64, s[44:47], 0 offen sc1
 s_waitcnt lgkmcnt(4)
 v_mfma_f32_32x32x16_bf16 v[160:175], a[224:227], a[84:87], v[160:175]
 s_mov_b32 s26, 57344
 buffer_load_dwordx4 a[116:119], v63, s[44:47], s26 offen offset:0 sc1
 ds_read_b64_tr_b16 a[232:233], v69 offset:16384
 ds_read_b64_tr_b16 a[234:235], v69 offset:17408
 ds_read_b64_tr_b16 a[236:237], v70 offset:16384
 ds_read_b64_tr_b16 a[238:239], v70 offset:17408
 v_mfma_f32_32x32x16_bf16 v[176:191], a[228:231], a[84:87], v[176:191]
 buffer_load_dwordx4 a[124:127], v63, s[44:47], s26 offen offset:2048 sc1
 v_mfma_f32_32x32x16_bf16 v[144:159], a[228:231], a[80:83], v[144:159]
 s_mov_b32 s26, 61440
 buffer_load_dwordx4 a[132:135], v63, s[44:47], s26 offen offset:0 sc1
 ds_read_b64_tr_b16 v[216:217], v69 offset:40960
 ds_read_b64_tr_b16 v[218:219], v69 offset:41984
 ds_read_b64_tr_b16 v[220:221], v70 offset:40960
 ds_read_b64_tr_b16 v[222:223], v70 offset:41984
 v_mfma_f32_32x32x16_bf16 v[128:143], a[224:227], a[80:83], v[128:143]
 s_waitcnt vmcnt(8) lgkmcnt(4)
 v_mfma_f32_32x32x16_bf16 v[160:175], a[232:235], a[92:95], v[160:175]
 buffer_load_dwordx4 a[140:143], v63, s[44:47], s26 offen offset:2048 sc1
 ds_read_b64_tr_b16 a[240:241], v71 offset:24576
 ds_read_b64_tr_b16 a[242:243], v71 offset:25600
 ds_read_b64_tr_b16 a[244:245], v72 offset:24576
 ds_read_b64_tr_b16 a[246:247], v72 offset:25600
 v_mfma_f32_32x32x16_bf16 v[176:191], a[236:239], a[92:95], v[176:191]
 s_mov_b32 s26, 65536
 buffer_load_dwordx4 a[148:151], v63, s[44:47], s26 offen offset:0 sc1
 v_mfma_f32_32x32x16_bf16 v[144:159], a[236:239], a[88:91], v[144:159]
 buffer_load_dwordx4 a[156:159], v63, s[44:47], s26 offen offset:2048 sc1
 ds_read_b64_tr_b16 v[224:225], v71 offset:0
 ds_read_b64_tr_b16 v[226:227], v71 offset:1024
 ds_read_b64_tr_b16 v[228:229], v72 offset:0
 ds_read_b64_tr_b16 v[230:231], v72 offset:1024
 v_mfma_f32_32x32x16_bf16 v[128:143], a[232:235], a[88:91], v[128:143]
 s_waitcnt vmcnt(9) lgkmcnt(4)
 v_mfma_f32_32x32x16_bf16 v[160:175], a[240:243], a[100:103], v[160:175]
 s_mov_b32 s26, 69632
 buffer_load_dwordx4 a[164:167], v63, s[44:47], s26 offen offset:0 sc1
 ds_read_b64_tr_b16 a[248:249], v73 offset:24576
 ds_read_b64_tr_b16 a[250:251], v73 offset:25600
 ds_read_b64_tr_b16 a[252:253], v74 offset:24576
 ds_read_b64_tr_b16 a[254:255], v74 offset:25600
 v_mfma_f32_32x32x16_bf16 v[176:191], a[244:247], a[100:103], v[176:191]
 s_mov_b32 s26, 57344
 buffer_load_dwordx4 a[112:115], v62, s[44:47], s26 offen offset:0 sc1
 s_waitcnt vmcnt(8)
 v_mov_b32 v65, v64
 v_mfma_f32_32x32x16_bf16 v[144:159], a[244:247], a[96:99], v[144:159]
 buffer_load_dwordx4 a[120:123], v62, s[44:47], s26 offen offset:2048 sc1
 ds_read_b64_tr_b16 v[232:233], v71 offset:49152
 ds_read_b64_tr_b16 v[234:235], v71 offset:50176
 ds_read_b64_tr_b16 v[236:237], v72 offset:49152
 ds_read_b64_tr_b16 v[238:239], v72 offset:50176
 v_permlane32_swap_b32 v64, v65
 v_mfma_f32_32x32x16_bf16 v[128:143], a[240:243], a[96:99], v[128:143]
 s_waitcnt lgkmcnt(4)
 v_mfma_f32_32x32x16_bf16 v[160:175], a[248:251], a[108:111], v[160:175]
 v_mfma_f32_32x32x16_bf16 v[176:191], a[252:255], a[108:111], v[176:191]
 s_mov_b32 s26, 61440
 buffer_load_dwordx4 a[128:131], v62, s[44:47], s26 offen offset:0 sc1
 ds_read_b64_tr_b16 v[192:193], v69 offset:49152
 ds_read_b64_tr_b16 v[194:195], v69 offset:50176
 ds_read_b64_tr_b16 v[196:197], v70 offset:49152
 ds_read_b64_tr_b16 v[198:199], v70 offset:50176
 ds_read_b64_tr_b16 v[240:241], v71 offset:57344
 ds_read_b64_tr_b16 v[242:243], v71 offset:58368
 ds_read_b64_tr_b16 v[244:245], v72 offset:57344
 ds_read_b64_tr_b16 v[246:247], v72 offset:58368
 v_mfma_f32_32x32x16_bf16 v[144:159], a[252:255], a[104:107], v[144:159]
 buffer_load_dwordx4 a[136:139], v62, s[44:47], s26 offen offset:2048 sc1
 v_mul_f32 v160, v160, v65
 v_mul_f32 v161, v161, v65
 v_mul_f32 v162, v162, v65
 v_mul_f32 v163, v163, v65
 v_mul_f32 v164, v164, v65
 v_mul_f32 v165, v165, v65
 v_mul_f32 v166, v166, v65
 v_mul_f32 v167, v167, v65
 v_mfma_f32_32x32x16_bf16 v[128:143], a[248:251], a[104:107], v[128:143]
 s_mov_b32 s26, 65536
 buffer_load_dwordx4 a[144:147], v62, s[44:47], s26 offen offset:0 sc1
 v_mul_f32 v168, v168, v65
 v_mul_f32 v169, v169, v65
 v_mul_f32 v170, v170, v65
 v_mul_f32 v171, v171, v65
 v_mul_f32 v172, v172, v65
 v_mul_f32 v173, v173, v65
 v_mul_f32 v174, v174, v65
 v_mul_f32 v175, v175, v65
 s_waitcnt lgkmcnt(0)
 s_waitcnt vmcnt(11)
 v_mfma_f32_32x32x16_bf16 v[160:175], v[192:195], a[116:119], v[160:175]
 buffer_load_dwordx4 a[152:155], v62, s[44:47], s26 offen offset:2048 sc1
 v_mul_f32 v176, v176, v65
 v_mul_f32 v177, v177, v65
 v_mul_f32 v178, v178, v65
 s_waitcnt vmcnt(11)
 v_mfma_f32_32x32x16_bf16 v[160:175], v[200:203], a[124:127], v[160:175]
 s_mov_b32 s26, 69632
 buffer_load_dwordx4 a[160:163], v62, s[44:47], s26 offen offset:0 sc1
 v_mul_f32 v179, v179, v65
 v_mul_f32 v180, v180, v65
 v_mul_f32 v181, v181, v65
 s_waitcnt vmcnt(11)
 v_mfma_f32_32x32x16_bf16 v[160:175], v[208:211], a[132:135], v[160:175]
 v_mul_f32 v182, v182, v65
 v_mul_f32 v183, v183, v65
 v_mul_f32 v184, v184, v65
 s_waitcnt vmcnt(10)
 v_mfma_f32_32x32x16_bf16 v[160:175], v[216:219], a[140:143], v[160:175]
 v_mul_f32 v185, v185, v65
 v_mul_f32 v186, v186, v65
 v_mul_f32 v187, v187, v65
 s_waitcnt vmcnt(9)
 v_mfma_f32_32x32x16_bf16 v[160:175], v[224:227], a[148:151], v[160:175]
 v_mul_f32 v188, v188, v65
 v_mul_f32 v189, v189, v65
 s_waitcnt vmcnt(8)
 v_mfma_f32_32x32x16_bf16 v[160:175], v[232:235], a[156:159], v[160:175]
 v_mul_f32 v190, v190, v65
 v_mul_f32 v191, v191, v65
 s_waitcnt vmcnt(7)
 v_mfma_f32_32x32x16_bf16 v[160:175], v[240:243], a[164:167], v[160:175]
 v_mfma_f32_32x32x16_bf16 v[176:191], v[196:199], a[116:119], v[176:191]
 v_mul_f32 v144, v144, v64
 v_mul_f32 v145, v145, v64
 v_mul_f32 v146, v146, v64
 v_mul_f32 v147, v147, v64
 v_mul_f32 v148, v148, v64
 v_mul_f32 v149, v149, v64
 v_mfma_f32_32x32x16_bf16 v[176:191], v[204:207], a[124:127], v[176:191]
 v_mul_f32 v150, v150, v64
 v_mul_f32 v151, v151, v64
 v_mul_f32 v152, v152, v64
 v_mul_f32 v153, v153, v64
 v_mul_f32 v154, v154, v64
 v_mul_f32 v155, v155, v64
 v_mfma_f32_32x32x16_bf16 v[176:191], v[212:215], a[132:135], v[176:191]
 ds_write_b128 v67, v[160:163] offset:16384
 v_mul_f32 v156, v156, v64
 v_mul_f32 v157, v157, v64
 v_mfma_f32_32x32x16_bf16 v[176:191], v[220:223], a[140:143], v[176:191]
 ds_write_b128 v67, v[164:167] offset:17408
 v_mul_f32 v158, v158, v64
 v_mul_f32 v159, v159, v64
 v_mfma_f32_32x32x16_bf16 v[176:191], v[228:231], a[148:151], v[176:191]
 ds_write_b128 v67, v[168:171] offset:24576
 v_mfma_f32_32x32x16_bf16 v[176:191], v[236:239], a[156:159], v[176:191]
 ds_write_b128 v67, v[172:175] offset:25600
 v_mfma_f32_32x32x16_bf16 v[176:191], v[244:247], a[164:167], v[176:191]
 s_waitcnt vmcnt(6)
 v_mfma_f32_32x32x16_bf16 v[144:159], v[196:199], a[112:115], v[144:159]
 v_mul_f32 v128, v128, v64
 v_mul_f32 v129, v129, v64
 v_mul_f32 v130, v130, v64
 v_mul_f32 v131, v131, v64
 v_mul_f32 v132, v132, v64
 v_mul_f32 v133, v133, v64
 s_waitcnt vmcnt(5)
 v_mfma_f32_32x32x16_bf16 v[144:159], v[204:207], a[120:123], v[144:159]
 v_mul_f32 v134, v134, v64
 v_mul_f32 v135, v135, v64
 v_mul_f32 v136, v136, v64
 v_mul_f32 v137, v137, v64
 v_mul_f32 v138, v138, v64
 v_mul_f32 v139, v139, v64
 s_waitcnt vmcnt(4)
 v_mfma_f32_32x32x16_bf16 v[144:159], v[212:215], a[128:131], v[144:159]
 ds_write_b128 v67, v[176:179] offset:32768
 v_mul_f32 v140, v140, v64
 v_mul_f32 v141, v141, v64
 s_waitcnt vmcnt(3)
 v_mfma_f32_32x32x16_bf16 v[144:159], v[220:223], a[136:139], v[144:159]
 ds_write_b128 v67, v[180:183] offset:33792
 v_mul_f32 v142, v142, v64
 v_mul_f32 v143, v143, v64
 s_waitcnt vmcnt(2)
 v_mfma_f32_32x32x16_bf16 v[144:159], v[228:231], a[144:147], v[144:159]
 ds_write_b128 v67, v[184:187] offset:40960
 s_waitcnt vmcnt(1)
 v_mfma_f32_32x32x16_bf16 v[144:159], v[236:239], a[152:155], v[144:159]
 ds_write_b128 v67, v[188:191] offset:41984
 s_waitcnt vmcnt(0)
 v_mfma_f32_32x32x16_bf16 v[144:159], v[244:247], a[160:163], v[144:159]
 v_mfma_f32_32x32x16_bf16 v[128:143], v[192:195], a[112:115], v[128:143]
 v_mfma_f32_32x32x16_bf16 v[128:143], v[200:203], a[120:123], v[128:143]
 v_mfma_f32_32x32x16_bf16 v[128:143], v[208:211], a[128:131], v[128:143]
 s_nop 8
 ds_write_b128 v67, v[144:147] offset:0
 v_mfma_f32_32x32x16_bf16 v[128:143], v[216:219], a[136:139], v[128:143]
 ds_write_b128 v67, v[148:151] offset:1024
 v_mfma_f32_32x32x16_bf16 v[128:143], v[224:227], a[144:147], v[128:143]
 ds_write_b128 v67, v[152:155] offset:8192
 v_mfma_f32_32x32x16_bf16 v[128:143], v[232:235], a[152:155], v[128:143]
 ds_write_b128 v67, v[156:159] offset:9216
 v_mfma_f32_32x32x16_bf16 v[128:143], v[240:243], a[160:163], v[128:143]
 s_waitcnt lgkmcnt(0)
 s_barrier
 ds_read_b128 v[160:163], v76 offset:16384
 ds_read_b128 v[164:167], v76 offset:17408
 ds_read_b128 v[176:179], v77 offset:32768
 ds_read_b128 v[180:183], v77 offset:33792
 ds_read_b128 v[144:147], v75 offset:0
 ds_read_b128 v[148:151], v75 offset:1024
 ds_read_b128 v[168:171], v76 offset:24576
 ds_read_b128 v[172:175], v76 offset:25600
 ds_read_b128 v[184:187], v77 offset:40960
 ds_read_b128 v[188:191], v77 offset:41984
 ds_read_b128 v[152:155], v75 offset:8192
 ds_read_b128 v[156:159], v75 offset:9216
 s_mov_b32 vcc_lo, 0x55555555
 s_mov_b32 vcc_hi, 0x55555555
 s_waitcnt lgkmcnt(10)
 v_pk_add_f32 v[128:129], v[128:129], v[160:161]
 v_pk_add_f32 v[130:131], v[130:131], v[162:163]
 v_pk_add_f32 v[132:133], v[132:133], v[164:165]
 v_pk_add_f32 v[134:135], v[134:135], v[166:167]
 s_waitcnt lgkmcnt(8)
 v_pk_add_f32 v[128:129], v[128:129], v[176:177]
 v_pk_add_f32 v[130:131], v[130:131], v[178:179]
 v_pk_add_f32 v[132:133], v[132:133], v[180:181]
 v_pk_add_f32 v[134:135], v[134:135], v[182:183]
 s_waitcnt lgkmcnt(6)
 v_pk_add_f32 v[128:129], v[128:129], v[144:145]
 v_pk_add_f32 v[130:131], v[130:131], v[146:147]
 v_pk_add_f32 v[132:133], v[132:133], v[148:149]
 v_pk_add_f32 v[134:135], v[134:135], v[150:151]
 v_cvt_pk_bf16_f32 v96, v128, v129
 v_cvt_pk_bf16_f32 v97, v130, v131
 v_cvt_pk_bf16_f32 v100, v132, v133
 v_cvt_pk_bf16_f32 v101, v134, v135
 s_waitcnt lgkmcnt(4)
 v_pk_add_f32 v[136:137], v[136:137], v[168:169]
 v_pk_add_f32 v[138:139], v[138:139], v[170:171]
 v_pk_add_f32 v[140:141], v[140:141], v[172:173]
 v_pk_add_f32 v[142:143], v[142:143], v[174:175]
 s_waitcnt lgkmcnt(2)
 v_pk_add_f32 v[136:137], v[136:137], v[184:185]
 v_pk_add_f32 v[138:139], v[138:139], v[186:187]
 v_pk_add_f32 v[140:141], v[140:141], v[188:189]
 v_pk_add_f32 v[142:143], v[142:143], v[190:191]
 s_waitcnt lgkmcnt(0)
 v_pk_add_f32 v[136:137], v[136:137], v[152:153]
 v_pk_add_f32 v[138:139], v[138:139], v[154:155]
 v_pk_add_f32 v[140:141], v[140:141], v[156:157]
 v_pk_add_f32 v[142:143], v[142:143], v[158:159]
 v_cvt_pk_bf16_f32 v98, v136, v137
 v_cvt_pk_bf16_f32 v99, v138, v139
 v_cvt_pk_bf16_f32 v102, v140, v141
 v_cvt_pk_bf16_f32 v103, v142, v143
 v_permlane32_swap_b32 v96, v98
 v_permlane32_swap_b32 v97, v99
 v_permlane32_swap_b32 v100, v102
 v_permlane32_swap_b32 v101, v103
 s_nop 0
 v_cndmask_b32_dpp v104, v100, v96, vcc quad_perm:[1,0,3,2] row_mask:0xf bank_mask:0xf
 v_cndmask_b32_dpp v105, v101, v97, vcc quad_perm:[1,0,3,2] row_mask:0xf bank_mask:0xf
 v_cndmask_b32_dpp v106, v102, v98, vcc quad_perm:[1,0,3,2] row_mask:0xf bank_mask:0xf
 v_cndmask_b32_dpp v107, v103, v99, vcc quad_perm:[1,0,3,2] row_mask:0xf bank_mask:0xf
 s_not_b64 vcc, vcc
 buffer_store_dwordx4 v[104:107], v66, s[60:63], 0 offen nt
 v_cndmask_b32_dpp v108, v96, v100, vcc quad_perm:[1,0,3,2] row_mask:0xf bank_mask:0xf
 v_cndmask_b32_dpp v109, v97, v101, vcc quad_perm:[1,0,3,2] row_mask:0xf bank_mask:0xf
 v_cndmask_b32_dpp v110, v98, v102, vcc quad_perm:[1,0,3,2] row_mask:0xf bank_mask:0xf
 v_cndmask_b32_dpp v111, v99, v103, vcc quad_perm:[1,0,3,2] row_mask:0xf bank_mask:0xf
 buffer_store_dwordx4 v[108:111], v66, s[60:63], 0 offen offset:896 nt
 s_endpgm
L_t3:
 s_mul_i32 s85, s72, 21504
 s_mul_i32 s86, s77, 448
 s_add_u32 s85, s85, s86
 v_mul_u32_u24 v51, 2688, v48
 v_add3_u32 v4, v51, v50, s85
 v_xor_b32 v52, 32, v50
 v_add3_u32 v5, v51, v52, s85
 s_mov_b32 s38, 1204224
 s_mov_b32 s39, 0x20000
 s_mov_b32 s42, 1205120
 s_mov_b32 s43, 0x20000
 s_mov_b32 s36, s6
 s_mov_b32 s37, s7
 s_sub_u32 s40, s6, 896
 s_subb_u32 s41, s7, 0
 s_add_u32 m0, s81, 106496
 s_mul_i32 s83, s94, 1344
 buffer_load_dwordx4 v4, s[36:39], s83 offen offset:0 lds
 buffer_load_dwordx4 v5, s[40:43], s83 offen offset:1024 lds
 s_add_u32 m0, s81, 114688
 s_add_u32 s83, s83, 86016
 buffer_load_dwordx4 v4, s[36:39], s83 offen offset:0 lds
 buffer_load_dwordx4 v5, s[40:43], s83 offen offset:1024 lds
 s_lshl2_add_u32 s85, s2, s72
 s_mul_i32 s85, s85, 10
 v_min_u32 v16, 9, v1
 v_add_lshl_u32 v16, v16, s85, 7
 buffer_load_dword v68, v16, s[32:35], 0 offen
 v_lshlrev_b32 v2, 4, v1
 v_lshlrev_b32 v3, 2, v1
 s_and_b32 s79, s2, 63
 s_lshl_b32 s80, s72, 10
 s_bfe_u32 s86, s2, 0x20004
 s_add_u32 s86, s86, 24
 s_cmp_eq_u32 s78, 3
 s_cselect_b32 s76, s86, s76
 s_mov_b32 s44, s24
 s_mov_b32 s45, s25
 s_mov_b32 s46, 13312000
 s_mov_b32 s47, 0x20000
 v_lshrrev_b32 v54, 5, v1
 v_bfe_u32 v53, v1, 2, 2
 v_lshlrev_b32 v53, 7, v53
 v_and_b32 v52, 3, v1
 v_lshl_add_u32 v53, v52, 3, v53
 v_bfe_u32 v52, v1, 3, 1
 v_lshl_add_u32 v53, v52, 6, v53
 v_bfe_u32 v55, v1, 4, 1
 v_lshl_add_u32 v53, v55, 5, v53
 v_and_b32 v56, 31, v1
 v_mov_b32 v12, 0x3f803f80
 s_mov_b32 s48, s22
 s_mov_b32 s49, s23
 s_mov_b32 s50, 256
 s_mov_b32 s51, 0x20000
 v_xor_b32 v52, v49, v54
 v_lshlrev_b32 v51, 7, v56
 v_lshl_add_u32 v51, v52, 4, v51
 v_add_u32 v17, s82, v51
 v_xor_b32 v18, 32, v17
 v_xor_b32 v19, 64, v17
 v_xor_b32 v20, 96, v17
 v_lshl_add_u32 v21, v54, 11, v53
 v_xor_b32 v22, 64, v21
 v_xor_b32 v23, 1056, v21
 v_xor_b32 v24, 1120, v21
 v_add_u32 v25, 65536, v21
 v_add_u32 v26, 65536, v22
 v_add_u32 v27, 65536, v23
 v_add_u32 v28, 65536, v24
 v_add_u32 v29, 131072, v21
 v_add_u32 v30, 131072, v22
 v_add_u32 v31, 131072, v23
 v_add_u32 v32, 131072, v24
 v_mov_b32 v96, 0x358637bd
 v_mov_b32 v97, v96
 v_mov_b32 v98, v96
 v_mov_b32 v99, v96
 v_mov_b32 v100, v96
 v_mov_b32 v101, v96
 v_mov_b32 v102, v96
 v_mov_b32 v103, v96
 v_mov_b32 v104, v96
 v_mov_b32 v105, v96
 v_mov_b32 v106, v96
 v_mov_b32 v107, v96
 v_mov_b32 v108, v96
 v_mov_b32 v109, v96
 v_mov_b32 v110, v96
 v_mov_b32 v111, v96
 v_and_b32 v33, 124, v3
 s_mov_b32 s89, 0x358637bd
 v_mov_b32 v91, 0xb5c1a2a0
 s_lshr_b32 s0, s72, 1
 s_lshl_b32 s1, s73, 1
 s_add_u32 s0, s0, s1
 s_mul_i32 s0, s0, 144
 s_mul_i32 s1, s77, 72
 s_add_u32 s1, s1, 28
 s_add_u32 s0, s0, s1
 s_lshl_b32 s0, s0, 1
 s_and_b32 s1, s72, 1
 s_mul_i32 s1, s1, 1
 s_add_u32 s0, s0, s1
 s_lshl_b32 s0, s0, 10
 v_add_u32 v8, s0, v2
 s_lshl1_add_u32 s0, s73, s77
 s_lshl2_add_u32 s0, s0, s72
 s_lshl_b32 s0, s0, 7
 s_add_u32 s27, s0, 13295616
 s_mov_b32 s64, s18
 s_mov_b32 s65, s19
 s_mov_b32 s66, 896
 s_mov_b32 s67, 0x20000
 v_lshlrev_b32 v14, 4, v54
 v_add_u32 v14, 49152, v14
 s_and_b32 s0, s73, 1
 s_xor_b32 s0, s0, 1
 s_mul_i32 s0, s0, 28
 s_lshl_b32 s92, 15, s0
 s_mov_b32 s93, s92
 s_mov_b32 s96, 0
 s_mov_b32 s97, -1
 v_mov_b32 v62, 0
 v_mov_b32 v92, v12
 v_mov_b32 v93, v12
 v_mov_b32 v94, v12
 v_mov_b32 v95, v12
 s_lshl_b32 s3, s77, 2
 s_add_u32 s3, s3, s72
 s_lshl_b32 s0, s3, 12
 s_mul_i32 s1, s73, 28
 s_and_b32 s1, s1, -8
 v_add_u32 v51, s1, v56
 v_lshrrev_b32 v51, 3, v51
 v_mul_u32_u24 v63, 33280, v51
 v_lshl_add_u32 v63, v54, 7, v63
 v_lshl_add_u32 v63, v49, 4, v63
 s_add_u32 s0, s0, 9437184
 v_add_u32 v63, s0, v63
 v_add_u32 v84, 1863680, v63
 v_bfe_u32 v51, v1, 2, 1
 v_mul_u32_u24 v51, 31, v51
 v_add_u32 v51, s1, v51
 v_lshrrev_b32 v51, 6, v51
 v_bfe_u32 v52, v1, 3, 1
 v_mad_u32_u24 v51, v52, 7, v51
 v_lshlrev_b32 v51, 2, v51
 v_mov_b32 v36, 0x2cba7430
 v_mov_b32 v37, 0x851d96
 v_lshrrev_b64 v[36:37], v51, v[36:37]
 v_and_b32 v51, 15, v36
 v_lshl_add_u32 v51, v55, 4, v51
 v_lshlrev_b32 v85, 7, v51
 s_lshl_b32 s99, s3, 12
 s_lshl_b32 s52, s99, 1
 s_add_u32 s52, s52, 13164544
 s_add_u32 s99, s99, 13246464
 v_and_b32 v86, 15, v1
 v_lshlrev_b32 v86, 7, v86
 s_lshl_b32 s0, s3, 11
 s_add_u32 s0, s0, 13279232
 v_add_u32 v86, s0, v86
 s_lshl_b32 s0, s73, 1
 s_add_u32 s0, s0, s77
 s_lshl_b32 s0, s0, 2
 s_add_u32 s0, s0, s72
 s_lshl_b32 s54, s0, 9
 s_add_u32 s54, s54, 13164544
 s_lshl_b32 s0, s0, 7
 s_add_u32 s10, s0, 13279232
 v_add_u32 v87, s82, v2
 v_add_u32 v87, 57344, v87
 v_add_u32 v89, 73728, v2
 v_and_b32 v51, 1, v1
 v_lshrrev_b32 v52, 1, v1
 v_lshlrev_b32 v52, 4, v52
 v_lshl_add_u32 v88, v51, 10, v52
 s_lshr_b32 s0, s72, 1
 s_lshl_b32 s0, s0, 11
 s_and_b32 s1, s72, 1
 s_lshl_b32 s1, s1, 9
 s_add_u32 s0, s0, s1
 s_add_u32 s0, s0, 57344
 v_add_u32 v88, s0, v88
 v_lshlrev_b32 v90, 3, v1
 s_and_b32 s0, s73, 1
 s_xor_b32 s0, s0, 1
 s_mul_i32 s0, s0, 7
 s_lshl_b32 s1, s72, 1
 s_add_u32 m0, s82, 16384
 s_addk_i32 s26, 128
 s_cmpk_eq_u32 s26, 896
 s_cselect_b32 s26, 0, s26
 buffer_load_dwordx4 v80, s[28:31], s26 offen offset:0 lds
 buffer_load_dwordx4 v81, s[28:31], s26 offen offset:1024 lds
 buffer_load_dwordx4 v82, s[28:31], s26 offen offset:2048 lds
 buffer_load_dwordx4 v83, s[28:31], s26 offen offset:3072 lds
 s_add_u32 m0, s81, 122880
 s_add_u32 s83, s83, 86016
 s_cmp_eq_u32 s83, 1204224
 s_cselect_b32 s83, 0, s83
 buffer_load_dwordx4 v4, s[36:39], s83 offen offset:0 lds
 buffer_load_dwordx4 v5, s[40:43], s83 offen offset:1024 lds
 s_add_u32 m0, s81, 131072
 s_add_u32 s83, s83, 86016
 buffer_load_dwordx4 v4, s[36:39], s83 offen offset:0 lds
 buffer_load_dwordx4 v5, s[40:43], s83 offen offset:1024 lds
 s_add_u32 m0, s82, 32768
 s_addk_i32 s26, 128
 s_cmpk_eq_u32 s26, 896
 s_cselect_b32 s26, 0, s26
 buffer_load_dwordx4 v80, s[28:31], s26 offen offset:0 lds
 buffer_load_dwordx4 v81, s[28:31], s26 offen offset:1024 lds
 s_waitcnt vmcnt(11)
 s_barrier
 ds_read_b128 a[0:3], v17 offset:0
 ds_read_b64_tr_b16 a[224:225], v25 offset:40960
 ds_read_b64_tr_b16 a[226:227], v25 offset:41472
 ds_read_b128 a[4:7], v18 offset:0
 ds_read_b64_tr_b16 a[228:229], v26 offset:40960
 ds_read_b64_tr_b16 a[230:231], v26 offset:41472
 ds_read_b128 a[8:11], v19 offset:0
 ds_read_b64_tr_b16 a[232:233], v27 offset:40960
 ds_read_b64_tr_b16 a[234:235], v27 offset:41472
 ds_read_b128 a[12:15], v20 offset:0
 ds_read_b64_tr_b16 a[236:237], v28 offset:40960
 ds_read_b64_tr_b16 a[238:239], v28 offset:41472
 ds_read_b64_tr_b16 a[240:241], v25 offset:45056
 ds_read_b64_tr_b16 a[242:243], v25 offset:45568
 s_waitcnt lgkmcnt(8)
 v_mfma_f32_32x32x16_bf16 v[128:143], a[224:227], a[0:3], v[96:111]
 buffer_load_dwordx4 v82, s[28:31], s26 offen offset:2048 lds
 ds_read_b64_tr_b16 a[244:245], v26 offset:45056
 ds_read_b64_tr_b16 a[246:247], v26 offset:45568
 v_add_u32 v51, s1, v51
 v_cmp_eq_u32_e64 s[56:57], s0, v51
 s_lshl_b32 s55, s72, 13
 s_add_u32 s55, s55, 73728
 v_mfma_f32_32x32x16_bf16 v[144:159], a[228:231], a[0:3], v[96:111]
 buffer_load_dwordx4 v83, s[28:31], s26 offen offset:3072 lds
 ds_read_b64_tr_b16 a[248:249], v27 offset:45056
 ds_read_b64_tr_b16 a[250:251], v27 offset:45568
 s_lshl4_add_u32 s53, s77, s73
 s_lshl2_add_u32 s53, s53, s72
 s_lshl_b32 s53, s53, 7
 s_waitcnt lgkmcnt(6)
 v_mfma_f32_32x32x16_bf16 v[160:175], a[232:235], a[0:3], v[96:111]
 s_add_u32 m0, s81, 139264
 s_add_u32 s83, s83, 86016
 s_cmp_eq_u32 s83, 1204224
 s_cselect_b32 s83, 0, s83
 buffer_load_dwordx4 v4, s[36:39], s83 offen offset:0 lds
 ds_read_b64_tr_b16 a[252:253], v28 offset:45056
 ds_read_b64_tr_b16 a[254:255], v28 offset:45568
 v_mfma_f32_32x32x16_bf16 v[176:191], a[236:239], a[0:3], v[96:111]
 ds_read_b64_tr_b16 a[224:225], v25 offset:49152
 ds_read_b64_tr_b16 a[226:227], v25 offset:49664
 s_add_u32 s53, s53, 13230080
 s_waitcnt lgkmcnt(6)
 v_mfma_f32_32x32x16_bf16 v[128:143], a[240:243], a[4:7], v[128:143]
 buffer_load_dwordx4 v5, s[40:43], s83 offen offset:1024 lds
 ds_read_b64_tr_b16 a[228:229], v26 offset:49152
 ds_read_b64_tr_b16 a[230:231], v26 offset:49664
 v_mfma_f32_32x32x16_bf16 v[144:159], a[244:247], a[4:7], v[144:159]
 s_add_u32 m0, s81, 147456
 s_add_u32 s83, s83, 86016
 buffer_load_dwordx4 v4, s[36:39], s83 offen offset:0 lds
 ds_read_b64_tr_b16 a[232:233], v27 offset:49152
 ds_read_b64_tr_b16 a[234:235], v27 offset:49664
 s_waitcnt lgkmcnt(6)
 v_mfma_f32_32x32x16_bf16 v[160:175], a[248:251], a[4:7], v[160:175]
 buffer_load_dwordx4 v5, s[40:43], s83 offen offset:1024 lds
 ds_read_b64_tr_b16 a[236:237], v28 offset:49152
 ds_read_b64_tr_b16 a[238:239], v28 offset:49664
 v_mfma_f32_32x32x16_bf16 v[176:191], a[252:255], a[4:7], v[176:191]
 ds_read_b64_tr_b16 a[240:241], v25 offset:53248
 ds_read_b64_tr_b16 a[242:243], v25 offset:53760
 s_waitcnt lgkmcnt(6)
 v_mfma_f32_32x32x16_bf16 v[128:143], a[224:227], a[8:11], v[128:143]
 ds_read_b64_tr_b16 a[244:245], v26 offset:53248
 ds_read_b64_tr_b16 a[246:247], v26 offset:53760
 v_mfma_f32_32x32x16_bf16 v[144:159], a[228:231], a[8:11], v[144:159]
 ds_read_b64_tr_b16 a[248:249], v27 offset:53248
 ds_read_b64_tr_b16 a[250:251], v27 offset:53760
 s_waitcnt lgkmcnt(6)
 v_mfma_f32_32x32x16_bf16 v[160:175], a[232:235], a[8:11], v[160:175]
 ds_read_b64_tr_b16 a[252:253], v28 offset:53248
 ds_read_b64_tr_b16 a[254:255], v28 offset:53760
 v_mfma_f32_32x32x16_bf16 v[176:191], a[236:239], a[8:11], v[176:191]
 s_waitcnt vmcnt(8)
 s_barrier
 ds_read_b128 a[16:19], v17 offset:16384
 ds_read_b64_tr_b16 a[224:225], v25 offset:57344
 ds_read_b64_tr_b16 a[226:227], v25 offset:57856
 s_waitcnt lgkmcnt(7)
 v_mfma_f32_32x32x16_bf16 v[128:143], a[240:243], a[12:15], v[128:143]
 s_add_u32 m0, s82, 0
 s_addk_i32 s26, 128
 s_cmpk_eq_u32 s26, 896
 s_cselect_b32 s26, 0, s26
 buffer_load_dwordx4 v80, s[28:31], s26 offen offset:0 lds
 ds_read_b128 a[20:23], v18 offset:16384
 ds_read_b64_tr_b16 a[228:229], v26 offset:57344
 ds_read_b64_tr_b16 a[230:231], v26 offset:57856
 v_mfma_f32_32x32x16_bf16 v[144:159], a[244:247], a[12:15], v[144:159]
 buffer_load_dwordx4 v81, s[28:31], s26 offen offset:1024 lds
 ds_read_b128 a[24:27], v19 offset:16384
 ds_read_b64_tr_b16 a[232:233], v27 offset:57344
 ds_read_b64_tr_b16 a[234:235], v27 offset:57856
 s_waitcnt lgkmcnt(9)
 v_mfma_f32_32x32x16_bf16 v[160:175], a[248:251], a[12:15], v[160:175]
 buffer_load_dwordx4 v82, s[28:31], s26 offen offset:2048 lds
 ds_read_b128 a[28:31], v20 offset:16384
 ds_read_b64_tr_b16 a[236:237], v28 offset:57344
 ds_read_b64_tr_b16 a[238:239], v28 offset:57856
 v_mfma_f32_32x32x16_bf16 v[176:191], a[252:255], a[12:15], v[176:191]
 buffer_load_dwordx4 v83, s[28:31], s26 offen offset:3072 lds
 ds_read_b64_tr_b16 a[240:241], v25 offset:61440
 ds_read_b64_tr_b16 a[242:243], v25 offset:61952
 s_waitcnt lgkmcnt(8)
 v_mfma_f32_32x32x16_bf16 v[128:143], a[224:227], a[16:19], v[128:143]
 s_add_u32 m0, s81, 155648
 s_add_u32 s83, s83, 86016
 s_cmp_eq_u32 s83, 1204224
 s_cselect_b32 s83, 0, s83
 buffer_load_dwordx4 v4, s[36:39], s83 offen offset:0 lds
 ds_read_b64_tr_b16 a[244:245], v26 offset:61440
 ds_read_b64_tr_b16 a[246:247], v26 offset:61952
 v_mfma_f32_32x32x16_bf16 v[144:159], a[228:231], a[16:19], v[144:159]
 ds_read_b64_tr_b16 a[248:249], v27 offset:61440
 ds_read_b64_tr_b16 a[250:251], v27 offset:61952
 s_waitcnt lgkmcnt(6)
 v_mfma_f32_32x32x16_bf16 v[160:175], a[232:235], a[16:19], v[160:175]
 buffer_load_dwordx4 v5, s[40:43], s83 offen offset:1024 lds
 ds_read_b64_tr_b16 a[252:253], v28 offset:61440
 ds_read_b64_tr_b16 a[254:255], v28 offset:61952
 v_mfma_f32_32x32x16_bf16 v[176:191], a[236:239], a[16:19], v[176:191]
 s_add_u32 m0, s81, 106496
 s_add_u32 s83, s83, 86016
 buffer_load_dwordx4 v4, s[36:39], s83 offen offset:0 lds
 ds_read_b64_tr_b16 a[224:225], v29 offset:0
 ds_read_b64_tr_b16 a[226:227], v29 offset:512
 s_waitcnt lgkmcnt(6)
 v_mfma_f32_32x32x16_bf16 v[128:143], a[240:243], a[20:23], v[128:143]
 buffer_load_dwordx4 v5, s[40:43], s83 offen offset:1024 lds
 ds_read_b64_tr_b16 a[228:229], v30 offset:0
 ds_read_b64_tr_b16 a[230:231], v30 offset:512
 v_mfma_f32_32x32x16_bf16 v[144:159], a[244:247], a[20:23], v[144:159]
 ds_read_b64_tr_b16 a[232:233], v31 offset:0
 ds_read_b64_tr_b16 a[234:235], v31 offset:512
 s_waitcnt lgkmcnt(6)
 v_mfma_f32_32x32x16_bf16 v[160:175], a[248:251], a[20:23], v[160:175]
 ds_read_b64_tr_b16 a[236:237], v32 offset:0
 ds_read_b64_tr_b16 a[238:239], v32 offset:512
 v_mfma_f32_32x32x16_bf16 v[176:191], a[252:255], a[20:23], v[176:191]
 ds_read_b64_tr_b16 a[240:241], v29 offset:4096
 ds_read_b64_tr_b16 a[242:243], v29 offset:4608
 s_waitcnt lgkmcnt(6)
 v_mfma_f32_32x32x16_bf16 v[128:143], a[224:227], a[24:27], v[128:143]
 ds_read_b64_tr_b16 a[244:245], v30 offset:4096
 ds_read_b64_tr_b16 a[246:247], v30 offset:4608
 v_mfma_f32_32x32x16_bf16 v[144:159], a[228:231], a[24:27], v[144:159]
 ds_read_b64_tr_b16 a[248:249], v31 offset:4096
 ds_read_b64_tr_b16 a[250:251], v31 offset:4608
 s_waitcnt lgkmcnt(6)
 v_mfma_f32_32x32x16_bf16 v[160:175], a[232:235], a[24:27], v[160:175]
 ds_read_b64_tr_b16 a[252:253], v32 offset:4096
 ds_read_b64_tr_b16 a[254:255], v32 offset:4608
 v_mfma_f32_32x32x16_bf16 v[176:191], a[236:239], a[24:27], v[176:191]
 s_waitcnt vmcnt(8)
 s_barrier
 ds_read_b128 a[32:35], v17 offset:32768
 ds_read_b64_tr_b16 a[224:225], v29 offset:8192
 ds_read_b64_tr_b16 a[226:227], v29 offset:8704
 s_waitcnt lgkmcnt(7)
 v_mfma_f32_32x32x16_bf16 v[128:143], a[240:243], a[28:31], v[128:143]
 s_add_u32 m0, s82, 16384
 s_addk_i32 s26, 128
 s_cmpk_eq_u32 s26, 896
 s_cselect_b32 s26, 0, s26
 buffer_load_dwordx4 v80, s[28:31], s26 offen offset:0 lds
 ds_read_b128 a[36:39], v18 offset:32768
 ds_read_b64_tr_b16 a[228:229], v30 offset:8192
 ds_read_b64_tr_b16 a[230:231], v30 offset:8704
 v_mfma_f32_32x32x16_bf16 v[144:159], a[244:247], a[28:31], v[144:159]
 buffer_load_dwordx4 v81, s[28:31], s26 offen offset:1024 lds
 ds_read_b128 a[40:43], v19 offset:32768
 ds_read_b64_tr_b16 a[232:233], v31 offset:8192
 ds_read_b64_tr_b16 a[234:235], v31 offset:8704
 s_waitcnt lgkmcnt(9)
 v_mfma_f32_32x32x16_bf16 v[160:175], a[248:251], a[28:31], v[160:175]
 buffer_load_dwordx4 v82, s[28:31], s26 offen offset:2048 lds
 ds_read_b128 a[44:47], v20 offset:32768
 ds_read_b64_tr_b16 a[236:237], v32 offset:8192
 ds_read_b64_tr_b16 a[238:239], v32 offset:8704
 v_mfma_f32_32x32x16_bf16 v[176:191], a[252:255], a[28:31], v[176:191]
 buffer_load_dwordx4 v83, s[28:31], s26 offen offset:3072 lds
 ds_read_b64_tr_b16 a[240:241], v29 offset:12288
 ds_read_b64_tr_b16 a[242:243], v29 offset:12800
 s_waitcnt lgkmcnt(8)
 v_mfma_f32_32x32x16_bf16 v[128:143], a[224:227], a[32:35], v[128:143]
 s_add_u32 m0, s81, 114688
 s_add_u32 s83, s83, 86016
 s_cmp_eq_u32 s83, 1204224
 s_cselect_b32 s83, 0, s83
 buffer_load_dwordx4 v4, s[36:39], s83 offen offset:0 lds
 ds_read_b64_tr_b16 a[244:245], v30 offset:12288
 ds_read_b64_tr_b16 a[246:247], v30 offset:12800
 v_mfma_f32_32x32x16_bf16 v[144:159], a[228:231], a[32:35], v[144:159]
 ds_read_b64_tr_b16 a[248:249], v31 offset:12288
 ds_read_b64_tr_b16 a[250:251], v31 offset:12800
 s_waitcnt lgkmcnt(6)
 v_mfma_f32_32x32x16_bf16 v[160:175], a[232:235], a[32:35], v[160:175]
 buffer_load_dwordx4 v5, s[40:43], s83 offen offset:1024 lds
 ds_read_b64_tr_b16 a[252:253], v32 offset:12288
 ds_read_b64_tr_b16 a[254:255], v32 offset:12800
 v_mfma_f32_32x32x16_bf16 v[176:191], a[236:239], a[32:35], v[176:191]
 s_add_u32 m0, s81, 122880
 s_add_u32 s83, s83, 86016
 buffer_load_dwordx4 v4, s[36:39], s83 offen offset:0 lds
 ds_read_b64_tr_b16 a[224:225], v29 offset:16384
 ds_read_b64_tr_b16 a[226:227], v29 offset:16896
 s_waitcnt lgkmcnt(6)
 v_mfma_f32_32x32x16_bf16 v[128:143], a[240:243], a[36:39], v[128:143]
 buffer_load_dwordx4 v5, s[40:43], s83 offen offset:1024 lds
 ds_read_b64_tr_b16 a[228:229], v30 offset:16384
 ds_read_b64_tr_b16 a[230:231], v30 offset:16896
 v_mfma_f32_32x32x16_bf16 v[144:159], a[244:247], a[36:39], v[144:159]
 ds_read_b64_tr_b16 a[232:233], v31 offset:16384
 ds_read_b64_tr_b16 a[234:235], v31 offset:16896
 s_waitcnt lgkmcnt(6)
 v_mfma_f32_32x32x16_bf16 v[160:175], a[248:251], a[36:39], v[160:175]
 ds_read_b64_tr_b16 a[236:237], v32 offset:16384
 ds_read_b64_tr_b16 a[238:239], v32 offset:16896
 v_mfma_f32_32x32x16_bf16 v[176:191], a[252:255], a[36:39], v[176:191]
 ds_read_b64_tr_b16 a[240:241], v29 offset:20480
 ds_read_b64_tr_b16 a[242:243], v29 offset:20992
 s_waitcnt lgkmcnt(6)
 v_mfma_f32_32x32x16_bf16 v[128:143], a[224:227], a[40:43], v[128:143]
 ds_read_b64_tr_b16 a[244:245], v30 offset:20480
 ds_read_b64_tr_b16 a[246:247], v30 offset:20992
 v_mfma_f32_32x32x16_bf16 v[144:159], a[228:231], a[40:43], v[144:159]
 ds_read_b64_tr_b16 a[248:249], v31 offset:20480
 ds_read_b64_tr_b16 a[250:251], v31 offset:20992
 s_waitcnt lgkmcnt(6)
 v_mfma_f32_32x32x16_bf16 v[160:175], a[232:235], a[40:43], v[160:175]
 ds_read_b64_tr_b16 a[252:253], v32 offset:20480
 ds_read_b64_tr_b16 a[254:255], v32 offset:20992
 v_mfma_f32_32x32x16_bf16 v[176:191], a[236:239], a[40:43], v[176:191]
 s_waitcnt vmcnt(8)
 s_barrier
 ds_read_b128 a[48:51], v17 offset:0
 ds_read_b64_tr_b16 a[224:225], v29 offset:24576
 ds_read_b64_tr_b16 a[226:227], v29 offset:25088
 s_waitcnt lgkmcnt(7)
 v_mfma_f32_32x32x16_bf16 v[128:143], a[240:243], a[44:47], v[128:143]
 s_add_u32 m0, s82, 32768
 s_addk_i32 s26, 128
 s_cmpk_eq_u32 s26, 896
 s_cselect_b32 s26, 0, s26
 buffer_load_dwordx4 v80, s[28:31], s26 offen offset:0 lds
 ds_read_b128 a[52:55], v18 offset:0
 ds_read_b64_tr_b16 a[228:229], v30 offset:24576
 ds_read_b64_tr_b16 a[230:231], v30 offset:25088
 v_mfma_f32_32x32x16_bf16 v[144:159], a[244:247], a[44:47], v[144:159]
 buffer_load_dwordx4 v81, s[28:31], s26 offen offset:1024 lds
 ds_read_b128 a[56:59], v19 offset:0
 ds_read_b64_tr_b16 a[232:233], v31 offset:24576
 ds_read_b64_tr_b16 a[234:235], v31 offset:25088
 s_waitcnt lgkmcnt(9)
 v_mfma_f32_32x32x16_bf16 v[160:175], a[248:251], a[44:47], v[160:175]
 buffer_load_dwordx4 v82, s[28:31], s26 offen offset:2048 lds
 ds_read_b128 a[60:63], v20 offset:0
 ds_read_b64_tr_b16 a[236:237], v32 offset:24576
 ds_read_b64_tr_b16 a[238:239], v32 offset:25088
 v_mfma_f32_32x32x16_bf16 v[176:191], a[252:255], a[44:47], v[176:191]
 buffer_load_dwordx4 v83, s[28:31], s26 offen offset:3072 lds
 ds_read_b64_tr_b16 a[240:241], v29 offset:28672
 ds_read_b64_tr_b16 a[242:243], v29 offset:29184
 s_waitcnt lgkmcnt(8)
 v_mfma_f32_32x32x16_bf16 v[128:143], a[224:227], a[48:51], v[128:143]
 s_add_u32 m0, s81, 131072
 s_add_u32 s83, s83, 86016
 s_cmp_eq_u32 s83, 1204224
 s_cselect_b32 s83, 0, s83
 buffer_load_dwordx4 v4, s[36:39], s83 offen offset:0 lds
 ds_read_b64_tr_b16 a[244:245], v30 offset:28672
 ds_read_b64_tr_b16 a[246:247], v30 offset:29184
 v_mfma_f32_32x32x16_bf16 v[144:159], a[228:231], a[48:51], v[144:159]
 ds_read_b64_tr_b16 a[248:249], v31 offset:28672
 ds_read_b64_tr_b16 a[250:251], v31 offset:29184
 s_waitcnt lgkmcnt(6)
 v_mfma_f32_32x32x16_bf16 v[160:175], a[232:235], a[48:51], v[160:175]
 buffer_load_dwordx4 v5, s[40:43], s83 offen offset:1024 lds
 ds_read_b64_tr_b16 a[252:253], v32 offset:28672
 ds_read_b64_tr_b16 a[254:255], v32 offset:29184
 v_mfma_f32_32x32x16_bf16 v[176:191], a[236:239], a[48:51], v[176:191]
 s_add_u32 m0, s81, 139264
 s_add_u32 s83, s83, 86016
 buffer_load_dwordx4 v4, s[36:39], s83 offen offset:0 lds
 ds_read_b64_tr_b16 a[224:225], v25 offset:40960
 ds_read_b64_tr_b16 a[226:227], v25 offset:41472
 s_waitcnt lgkmcnt(6)
 v_mfma_f32_32x32x16_bf16 v[128:143], a[240:243], a[52:55], v[128:143]
 buffer_load_dwordx4 v5, s[40:43], s83 offen offset:1024 lds
 ds_read_b64_tr_b16 a[228:229], v26 offset:40960
 ds_read_b64_tr_b16 a[230:231], v26 offset:41472
 v_mfma_f32_32x32x16_bf16 v[144:159], a[244:247], a[52:55], v[144:159]
 ds_read_b64_tr_b16 a[232:233], v27 offset:40960
 ds_read_b64_tr_b16 a[234:235], v27 offset:41472
 s_waitcnt lgkmcnt(6)
 v_mfma_f32_32x32x16_bf16 v[160:175], a[248:251], a[52:55], v[160:175]
 ds_read_b64_tr_b16 a[236:237], v28 offset:40960
 ds_read_b64_tr_b16 a[238:239], v28 offset:41472
 v_mfma_f32_32x32x16_bf16 v[176:191], a[252:255], a[52:55], v[176:191]
 ds_read_b64_tr_b16 a[240:241], v25 offset:45056
 ds_read_b64_tr_b16 a[242:243], v25 offset:45568
 s_waitcnt lgkmcnt(6)
 v_mfma_f32_32x32x16_bf16 v[128:143], a[224:227], a[56:59], v[128:143]
 ds_read_b64_tr_b16 a[244:245], v26 offset:45056
 ds_read_b64_tr_b16 a[246:247], v26 offset:45568
 v_mfma_f32_32x32x16_bf16 v[144:159], a[228:231], a[56:59], v[144:159]
 ds_read_b64_tr_b16 a[248:249], v27 offset:45056
 ds_read_b64_tr_b16 a[250:251], v27 offset:45568
 s_waitcnt lgkmcnt(6)
 v_mfma_f32_32x32x16_bf16 v[160:175], a[232:235], a[56:59], v[160:175]
 ds_read_b64_tr_b16 a[252:253], v28 offset:45056
 ds_read_b64_tr_b16 a[254:255], v28 offset:45568
 v_mfma_f32_32x32x16_bf16 v[176:191], a[236:239], a[56:59], v[176:191]
 s_waitcnt vmcnt(8)
 s_barrier
 s_mov_b32 m0, 49152
 v_add_u32 v51, s94, v2
 v_subrev_u32 v52, 896, v51
 v_min_u32 v51, v51, v52
 buffer_load_dwordx4 v51, s[64:67], 0 offen lds
 ds_read_b128 a[64:67], v17 offset:16384
 ds_read_b64_tr_b16 a[224:225], v25 offset:49152
 ds_read_b64_tr_b16 a[226:227], v25 offset:49664
 s_waitcnt lgkmcnt(7)
 v_mfma_f32_32x32x16_bf16 v[128:143], a[240:243], a[60:63], v[128:143]
 s_add_u32 m0, s82, 0
 s_addk_i32 s26, 128
 s_cmpk_eq_u32 s26, 896
 s_cselect_b32 s26, 0, s26
 buffer_load_dwordx4 v80, s[28:31], s26 offen offset:0 lds
 ds_read_b128 a[68:71], v18 offset:16384
 ds_read_b64_tr_b16 a[228:229], v26 offset:49152
 ds_read_b64_tr_b16 a[230:231], v26 offset:49664
 v_mfma_f32_32x32x16_bf16 v[144:159], a[244:247], a[60:63], v[144:159]
 buffer_load_dwordx4 v81, s[28:31], s26 offen offset:1024 lds
 ds_read_b128 a[72:75], v19 offset:16384
 ds_read_b64_tr_b16 a[232:233], v27 offset:49152
 ds_read_b64_tr_b16 a[234:235], v27 offset:49664
 s_waitcnt lgkmcnt(9)
 v_mfma_f32_32x32x16_bf16 v[160:175], a[248:251], a[60:63], v[160:175]
 buffer_load_dwordx4 v82, s[28:31], s26 offen offset:2048 lds
 ds_read_b128 a[76:79], v20 offset:16384
 ds_read_b64_tr_b16 a[236:237], v28 offset:49152
 ds_read_b64_tr_b16 a[238:239], v28 offset:49664
 v_mfma_f32_32x32x16_bf16 v[176:191], a[252:255], a[60:63], v[176:191]
 buffer_load_dwordx4 v83, s[28:31], s26 offen offset:3072 lds
 ds_read_b64_tr_b16 a[240:241], v25 offset:53248
 ds_read_b64_tr_b16 a[242:243], v25 offset:53760
 s_waitcnt lgkmcnt(8)
 v_mfma_f32_32x32x16_bf16 v[128:143], a[224:227], a[64:67], v[128:143]
 s_add_u32 m0, s81, 147456
 s_add_u32 s83, s83, 86016
 s_cmp_eq_u32 s83, 1204224
 s_cselect_b32 s83, 0, s83
 buffer_load_dwordx4 v4, s[36:39], s83 offen offset:0 lds
 ds_read_b64_tr_b16 a[244:245], v26 offset:53248
 ds_read_b64_tr_b16 a[246:247], v26 offset:53760
 v_mfma_f32_32x32x16_bf16 v[144:159], a[228:231], a[64:67], v[144:159]
 ds_read_b64_tr_b16 a[248:249], v27 offset:53248
 ds_read_b64_tr_b16 a[250:251], v27 offset:53760
 s_waitcnt lgkmcnt(6)
 v_mfma_f32_32x32x16_bf16 v[160:175], a[232:235], a[64:67], v[160:175]
 buffer_load_dwordx4 v5, s[40:43], s83 offen offset:1024 lds
 ds_read_b64_tr_b16 a[252:253], v28 offset:53248
 ds_read_b64_tr_b16 a[254:255], v28 offset:53760
 v_mfma_f32_32x32x16_bf16 v[176:191], a[236:239], a[64:67], v[176:191]
 s_add_u32 m0, s81, 155648
 s_add_u32 s83, s83, 86016
 buffer_load_dwordx4 v4, s[36:39], s83 offen offset:0 lds
 ds_read_b64_tr_b16 a[224:225], v25 offset:57344
 ds_read_b64_tr_b16 a[226:227], v25 offset:57856
 s_waitcnt lgkmcnt(6)
 v_mfma_f32_32x32x16_bf16 v[128:143], a[240:243], a[68:71], v[128:143]
 buffer_load_dwordx4 v5, s[40:43], s83 offen offset:1024 lds
 ds_read_b64_tr_b16 a[228:229], v26 offset:57344
 ds_read_b64_tr_b16 a[230:231], v26 offset:57856
 v_mfma_f32_32x32x16_bf16 v[144:159], a[244:247], a[68:71], v[144:159]
 ds_read_b64_tr_b16 a[232:233], v27 offset:57344
 ds_read_b64_tr_b16 a[234:235], v27 offset:57856
 s_waitcnt lgkmcnt(6)
 v_mfma_f32_32x32x16_bf16 v[160:175], a[248:251], a[68:71], v[160:175]
 ds_read_b64_tr_b16 a[236:237], v28 offset:57344
 ds_read_b64_tr_b16 a[238:239], v28 offset:57856
 v_mfma_f32_32x32x16_bf16 v[176:191], a[252:255], a[68:71], v[176:191]
 ds_read_b64_tr_b16 a[240:241], v25 offset:61440
 ds_read_b64_tr_b16 a[242:243], v25 offset:61952
 s_waitcnt lgkmcnt(6)
 v_mfma_f32_32x32x16_bf16 v[128:143], a[224:227], a[72:75], v[128:143]
 ds_read_b64_tr_b16 a[244:245], v26 offset:61440
 ds_read_b64_tr_b16 a[246:247], v26 offset:61952
 v_mfma_f32_32x32x16_bf16 v[144:159], a[228:231], a[72:75], v[144:159]
 ds_read_b64_tr_b16 a[248:249], v27 offset:61440
 ds_read_b64_tr_b16 a[250:251], v27 offset:61952
 s_waitcnt lgkmcnt(6)
 v_mfma_f32_32x32x16_bf16 v[160:175], a[232:235], a[72:75], v[160:175]
 ds_read_b64_tr_b16 a[252:253], v28 offset:61440
 ds_read_b64_tr_b16 a[254:255], v28 offset:61952
 v_mfma_f32_32x32x16_bf16 v[176:191], a[236:239], a[72:75], v[176:191]
 s_waitcnt vmcnt(9)
 s_barrier
 ds_read_b128 a[80:83], v17 offset:32768
 ds_read_b64_tr_b16 a[224:225], v29 offset:0
 ds_read_b64_tr_b16 a[226:227], v29 offset:512
 s_waitcnt lgkmcnt(7)
 v_mfma_f32_32x32x16_bf16 v[128:143], a[240:243], a[76:79], v[128:143]
 s_add_u32 m0, s81, 106496
 s_mul_i32 s83, s94, 1344
 s_addk_i32 s83, 256
 buffer_load_dwordx4 v4, s[36:39], s83 offen offset:0 lds
 ds_read_b128 a[84:87], v18 offset:32768
 ds_read_b64_tr_b16 a[228:229], v30 offset:0
 ds_read_b64_tr_b16 a[230:231], v30 offset:512
 v_mfma_f32_32x32x16_bf16 v[144:159], a[244:247], a[76:79], v[144:159]
 buffer_load_dwordx4 v5, s[40:43], s83 offen offset:1024 lds
 ds_read_b128 a[88:91], v19 offset:32768
 ds_read_b64_tr_b16 a[232:233], v31 offset:0
 ds_read_b64_tr_b16 a[234:235], v31 offset:512
 s_waitcnt lgkmcnt(9)
 v_mfma_f32_32x32x16_bf16 v[160:175], a[248:251], a[76:79], v[160:175]
 s_add_u32 m0, s81, 114688
 s_add_u32 s83, s83, 86016
 buffer_load_dwordx4 v4, s[36:39], s83 offen offset:0 lds
 ds_read_b128 a[92:95], v20 offset:32768
 ds_read_b64_tr_b16 a[236:237], v32 offset:0
 ds_read_b64_tr_b16 a[238:239], v32 offset:512
 v_mfma_f32_32x32x16_bf16 v[176:191], a[252:255], a[76:79], v[176:191]
 buffer_load_dwordx4 v5, s[40:43], s83 offen offset:1024 lds
 ds_read_b64_tr_b16 a[240:241], v29 offset:4096
 ds_read_b64_tr_b16 a[242:243], v29 offset:4608
 s_waitcnt lgkmcnt(8)
 v_mfma_f32_32x32x16_bf16 v[128:143], a[224:227], a[80:83], v[128:143]
 ds_read_b64_tr_b16 a[244:245], v30 offset:4096
 ds_read_b64_tr_b16 a[246:247], v30 offset:4608
 v_mfma_f32_32x32x16_bf16 v[144:159], a[228:231], a[80:83], v[144:159]
 ds_read_b64_tr_b16 a[248:249], v31 offset:4096
 ds_read_b64_tr_b16 a[250:251], v31 offset:4608
 s_waitcnt lgkmcnt(6)
 v_mfma_f32_32x32x16_bf16 v[160:175], a[232:235], a[80:83], v[160:175]
 ds_read_b64_tr_b16 a[252:253], v32 offset:4096
 ds_read_b64_tr_b16 a[254:255], v32 offset:4608
 v_mfma_f32_32x32x16_bf16 v[176:191], a[236:239], a[80:83], v[176:191]
 ds_read_b64_tr_b16 a[224:225], v29 offset:8192
 ds_read_b64_tr_b16 a[226:227], v29 offset:8704
 s_waitcnt lgkmcnt(6)
 v_mfma_f32_32x32x16_bf16 v[128:143], a[240:243], a[84:87], v[128:143]
 ds_read_b64_tr_b16 a[228:229], v30 offset:8192
 ds_read_b64_tr_b16 a[230:231], v30 offset:8704
 v_mfma_f32_32x32x16_bf16 v[144:159], a[244:247], a[84:87], v[144:159]
 ds_read_b64_tr_b16 a[232:233], v31 offset:8192
 ds_read_b64_tr_b16 a[234:235], v31 offset:8704
 s_waitcnt lgkmcnt(6)
 v_mfma_f32_32x32x16_bf16 v[160:175], a[248:251], a[84:87], v[160:175]
 ds_read_b64_tr_b16 a[236:237], v32 offset:8192
 ds_read_b64_tr_b16 a[238:239], v32 offset:8704
 v_mfma_f32_32x32x16_bf16 v[176:191], a[252:255], a[84:87], v[176:191]
 ds_read_b64_tr_b16 a[240:241], v29 offset:12288
 ds_read_b64_tr_b16 a[242:243], v29 offset:12800
 s_waitcnt lgkmcnt(6)
 v_mfma_f32_32x32x16_bf16 v[128:143], a[224:227], a[88:91], v[128:143]
 ds_read_b64_tr_b16 a[244:245], v30 offset:12288
 ds_read_b64_tr_b16 a[246:247], v30 offset:12800
 v_mfma_f32_32x32x16_bf16 v[144:159], a[228:231], a[88:91], v[144:159]
 ds_read_b64_tr_b16 a[248:249], v31 offset:12288
 ds_read_b64_tr_b16 a[250:251], v31 offset:12800
 s_waitcnt lgkmcnt(6)
 v_mfma_f32_32x32x16_bf16 v[160:175], a[232:235], a[88:91], v[160:175]
 ds_read_b64_tr_b16 a[252:253], v32 offset:12288
 ds_read_b64_tr_b16 a[254:255], v32 offset:12800
 v_mfma_f32_32x32x16_bf16 v[176:191], a[236:239], a[88:91], v[176:191]
 s_waitcnt vmcnt(4)
 s_barrier
 v_min_u32 v59, 60, v3
 buffer_load_dword v13, v59, s[48:51], 0 offen sc1
 ds_read_b128 a[96:99], v17 offset:0
 ds_read_b64_tr_b16 a[224:225], v29 offset:16384
 ds_read_b64_tr_b16 a[226:227], v29 offset:16896
 s_waitcnt lgkmcnt(7)
 v_mfma_f32_32x32x16_bf16 v[128:143], a[240:243], a[92:95], v[128:143]
 ds_read_b128 a[100:103], v18 offset:0
 ds_read_b64_tr_b16 a[228:229], v30 offset:16384
 ds_read_b64_tr_b16 a[230:231], v30 offset:16896
 v_mfma_f32_32x32x16_bf16 v[144:159], a[244:247], a[92:95], v[144:159]
 s_add_u32 m0, s81, 122880
 s_add_u32 s83, s83, 86016
 s_cmp_eq_u32 s83, 1204480
 s_cselect_b32 s83, 256, s83
 buffer_load_dwordx4 v4, s[36:39], s83 offen offset:0 lds
 ds_read_b128 a[104:107], v19 offset:0
 ds_read_b64_tr_b16 a[232:233], v31 offset:16384
 ds_read_b64_tr_b16 a[234:235], v31 offset:16896
 s_waitcnt lgkmcnt(9)
 v_mfma_f32_32x32x16_bf16 v[160:175], a[248:251], a[92:95], v[160:175]
 ds_read_b128 a[108:111], v20 offset:0
 ds_read_b64_tr_b16 a[236:237], v32 offset:16384
 ds_read_b64_tr_b16 a[238:239], v32 offset:16896
 v_mfma_f32_32x32x16_bf16 v[176:191], a[252:255], a[92:95], v[176:191]
 buffer_load_dwordx4 v5, s[40:43], s83 offen offset:1024 lds
 ds_read_b64_tr_b16 a[240:241], v29 offset:20480
 ds_read_b64_tr_b16 a[242:243], v29 offset:20992
 s_waitcnt lgkmcnt(8)
 v_mfma_f32_32x32x16_bf16 v[128:143], a[224:227], a[96:99], v[128:143]
 ds_read_b64_tr_b16 a[244:245], v30 offset:20480
 ds_read_b64_tr_b16 a[246:247], v30 offset:20992
 v_mfma_f32_32x32x16_bf16 v[144:159], a[228:231], a[96:99], v[144:159]
 s_add_u32 m0, s81, 131072
 s_add_u32 s83, s83, 86016
 buffer_load_dwordx4 v4, s[36:39], s83 offen offset:0 lds
 ds_read_b64_tr_b16 a[248:249], v31 offset:20480
 ds_read_b64_tr_b16 a[250:251], v31 offset:20992
 s_waitcnt lgkmcnt(6)
 v_mfma_f32_32x32x16_bf16 v[160:175], a[232:235], a[96:99], v[160:175]
 ds_read_b64_tr_b16 a[252:253], v32 offset:20480
 ds_read_b64_tr_b16 a[254:255], v32 offset:20992
 v_mfma_f32_32x32x16_bf16 v[176:191], a[236:239], a[96:99], v[176:191]
 buffer_load_dwordx4 v5, s[40:43], s83 offen offset:1024 lds
 ds_read_b64_tr_b16 a[224:225], v29 offset:24576
 ds_read_b64_tr_b16 a[226:227], v29 offset:25088
 s_waitcnt lgkmcnt(6)
 v_mfma_f32_32x32x16_bf16 v[128:143], a[240:243], a[100:103], v[128:143]
 ds_read_b64_tr_b16 a[228:229], v30 offset:24576
 ds_read_b64_tr_b16 a[230:231], v30 offset:25088
 v_mfma_f32_32x32x16_bf16 v[144:159], a[244:247], a[100:103], v[144:159]
 s_add_u32 m0, s81, 16384
 s_add_u32 s83, s83, 86016
 s_cmp_eq_u32 s83, 1204480
 s_cselect_b32 s83, 256, s83
 buffer_load_dwordx4 v4, s[36:39], s83 offen offset:0 lds
 ds_read_b64_tr_b16 a[232:233], v31 offset:24576
 ds_read_b64_tr_b16 a[234:235], v31 offset:25088
 s_waitcnt lgkmcnt(6)
 v_mfma_f32_32x32x16_bf16 v[160:175], a[248:251], a[100:103], v[160:175]
 ds_read_b64_tr_b16 a[236:237], v32 offset:24576
 ds_read_b64_tr_b16 a[238:239], v32 offset:25088
 v_mfma_f32_32x32x16_bf16 v[176:191], a[252:255], a[100:103], v[176:191]
 buffer_load_dwordx4 v5, s[40:43], s83 offen offset:1024 lds
 ds_read_b64_tr_b16 a[240:241], v29 offset:28672
 ds_read_b64_tr_b16 a[242:243], v29 offset:29184
 s_waitcnt lgkmcnt(6)
 v_mfma_f32_32x32x16_bf16 v[128:143], a[224:227], a[104:107], v[128:143]
 ds_read_b64_tr_b16 a[244:245], v30 offset:28672
 ds_read_b64_tr_b16 a[246:247], v30 offset:29184
 v_mfma_f32_32x32x16_bf16 v[144:159], a[228:231], a[104:107], v[144:159]
 s_add_u32 m0, s81, 24576
 s_add_u32 s83, s83, 86016
 buffer_load_dwordx4 v4, s[36:39], s83 offen offset:0 lds
 ds_read_b64_tr_b16 a[248:249], v31 offset:28672
 ds_read_b64_tr_b16 a[250:251], v31 offset:29184
 s_waitcnt lgkmcnt(6)
 v_mfma_f32_32x32x16_bf16 v[160:175], a[232:235], a[104:107], v[160:175]
 ds_read_b64_tr_b16 a[252:253], v32 offset:28672
 ds_read_b64_tr_b16 a[254:255], v32 offset:29184
 v_mfma_f32_32x32x16_bf16 v[176:191], a[236:239], a[104:107], v[176:191]
 buffer_load_dwordx4 v5, s[40:43], s83 offen offset:1024 lds
 s_waitcnt vmcnt(9)
 s_barrier
 ds_read_b64_tr_b16 a[224:225], v25 offset:40960
 ds_read_b64_tr_b16 a[226:227], v25 offset:41472
 s_waitcnt lgkmcnt(6)
 v_mfma_f32_32x32x16_bf16 v[128:143], a[240:243], a[108:111], v[128:143]
 s_add_u32 m0, s81, 139264
 s_add_u32 s83, s83, 86016
 s_cmp_eq_u32 s83, 1204480
 s_cselect_b32 s83, 256, s83
 buffer_load_dwordx4 v4, s[36:39], s83 offen offset:0 lds
 ds_read_b64_tr_b16 a[228:229], v26 offset:40960
 ds_read_b64_tr_b16 a[230:231], v26 offset:41472
 v_mfma_f32_32x32x16_bf16 v[144:159], a[244:247], a[108:111], v[144:159]
 ds_read_b64_tr_b16 a[232:233], v27 offset:40960
 ds_read_b64_tr_b16 a[234:235], v27 offset:41472
 s_waitcnt lgkmcnt(6)
 v_mfma_f32_32x32x16_bf16 v[160:175], a[248:251], a[108:111], v[160:175]
 buffer_load_dwordx4 v5, s[40:43], s83 offen offset:1024 lds
 ds_read_b128 a[236:239], v14 offset:0
 v_mfma_f32_32x32x16_bf16 v[176:191], a[252:255], a[108:111], v[176:191]
 ds_read_b64_tr_b16 a[240:241], v25 offset:45056
 ds_read_b64_tr_b16 a[242:243], v25 offset:45568
 s_waitcnt lgkmcnt(5)
 v_mfma_f32_32x32x16_bf16 v[192:207], a[224:227], a[0:3], v[96:111]
 s_add_u32 m0, s81, 147456
 s_add_u32 s83, s83, 86016
 buffer_load_dwordx4 v4, s[36:39], s83 offen offset:0 lds
 ds_read_b64_tr_b16 a[244:245], v26 offset:45056
 ds_read_b64_tr_b16 a[246:247], v26 offset:45568
 v_mfma_f32_32x32x16_bf16 v[208:223], a[228:231], a[0:3], v[96:111]
 ds_read_b64_tr_b16 a[248:249], v27 offset:45056
 ds_read_b64_tr_b16 a[250:251], v27 offset:45568
 s_waitcnt lgkmcnt(6)
 v_mfma_f32_32x32x16_bf16 v[224:239], a[232:235], a[0:3], v[96:111]
 buffer_load_dwordx4 v5, s[40:43], s83 offen offset:1024 lds
 ds_read_b128 a[252:255], v14 offset:32
 v_fmamk_f32 v36, v128, 0x3fb8aa3b, v91
 v_fmamk_f32 v37, v129, 0x3fb8aa3b, v91
 v_fmamk_f32 v38, v130, 0x3fb8aa3b, v91
 v_fmamk_f32 v39, v131, 0x3fb8aa3b, v91
 v_mfma_f32_32x32x16_bf16 v[240:255], a[236:239], a[0:3], 0
 ds_read_b64_tr_b16 a[224:225], v25 offset:49152
 ds_read_b64_tr_b16 a[226:227], v25 offset:49664
 v_exp_f32_e64 v36, v36 clamp
 v_max_f32 v128, s89, v128
 s_waitcnt lgkmcnt(5)
 v_mfma_f32_32x32x16_bf16 v[192:207], a[240:243], a[4:7], v[192:207]
 s_add_u32 m0, s81, 32768
 s_add_u32 s83, s83, 86016
 s_cmp_eq_u32 s83, 1204480
 s_cselect_b32 s83, 256, s83
 buffer_load_dwordx4 v4, s[36:39], s83 offen offset:0 lds
 ds_read_b64_tr_b16 a[228:229], v26 offset:49152
 ds_read_b64_tr_b16 a[230:231], v26 offset:49664
 v_mfma_f32_32x32x16_bf16 v[208:223], a[244:247], a[4:7], v[208:223]
 ds_read_b64_tr_b16 a[232:233], v27 offset:49152
 ds_read_b64_tr_b16 a[234:235], v27 offset:49664
 v_exp_f32_e64 v37, v37 clamp
 v_max_f32 v129, s89, v129
 s_waitcnt lgkmcnt(6)
 v_mfma_f32_32x32x16_bf16 v[224:239], a[248:251], a[4:7], v[224:239]
 buffer_load_dwordx4 v5, s[40:43], s83 offen offset:1024 lds
 ds_read_b128 a[236:239], v14 offset:64
 v_exp_f32_e64 v38, v38 clamp
 v_max_f32 v130, s89, v130
 v_mfma_f32_32x32x16_bf16 v[240:255], a[252:255], a[4:7], v[240:255]
 ds_read_b64_tr_b16 a[240:241], v25 offset:53248
 ds_read_b64_tr_b16 a[242:243], v25 offset:53760
 v_exp_f32_e64 v39, v39 clamp
 v_max_f32 v131, s89, v131
 s_waitcnt lgkmcnt(5)
 v_mfma_f32_32x32x16_bf16 v[192:207], a[224:227], a[8:11], v[192:207]
 s_add_u32 m0, s81, 40960
 s_add_u32 s83, s83, 86016
 buffer_load_dwordx4 v4, s[36:39], s83 offen offset:0 lds
 ds_read_b64_tr_b16 a[244:245], v26 offset:53248
 ds_read_b64_tr_b16 a[246:247], v26 offset:53760
 v_add_f32 v128, v128, v36
 v_mfma_f32_32x32x16_bf16 v[208:223], a[228:231], a[8:11], v[208:223]
 ds_read_b64_tr_b16 a[248:249], v27 offset:53248
 ds_read_b64_tr_b16 a[250:251], v27 offset:53760
 v_add_f32 v129, v129, v37
 v_add_f32 v130, v130, v38
 v_add_f32 v131, v131, v39
 s_waitcnt lgkmcnt(6)
 v_mfma_f32_32x32x16_bf16 v[224:239], a[232:235], a[8:11], v[224:239]
 buffer_load_dwordx4 v5, s[40:43], s83 offen offset:1024 lds
 ds_read_b128 a[252:255], v14 offset:96
 v_fmamk_f32 v36, v132, 0x3fb8aa3b, v91
 v_fmamk_f32 v37, v133, 0x3fb8aa3b, v91
 v_fmamk_f32 v38, v134, 0x3fb8aa3b, v91
 v_fmamk_f32 v39, v135, 0x3fb8aa3b, v91
 v_mfma_f32_32x32x16_bf16 v[240:255], a[236:239], a[8:11], v[240:255]
 s_waitcnt vmcnt(12)
 s_barrier
 v_cmp_lt_u32 vcc, 0, v13
 s_nop 0
 s_cmp_eq_u64 vcc, -1
 s_cbranch_scc0 L_spin_z3
L_ok_z3:
 ds_read_b64_tr_b16 a[224:225], v25 offset:57344
 ds_read_b64_tr_b16 a[226:227], v25 offset:57856
 s_waitcnt lgkmcnt(5)
 v_mfma_f32_32x32x16_bf16 v[192:207], a[240:243], a[12:15], v[192:207]
 s_add_u32 m0, s81, 155648
 s_add_u32 s83, s83, 86016
 s_cmp_eq_u32 s83, 1204480
 s_cselect_b32 s83, 256, s83
 buffer_load_dwordx4 v4, s[36:39], s83 offen offset:0 lds
 ds_read_b64_tr_b16 a[228:229], v26 offset:57344
 ds_read_b64_tr_b16 a[230:231], v26 offset:57856
 v_mfma_f32_32x32x16_bf16 v[208:223], a[244:247], a[12:15], v[208:223]
 ds_read_b64_tr_b16 a[232:233], v27 offset:57344
 ds_read_b64_tr_b16 a[234:235], v27 offset:57856
 v_exp_f32_e64 v36, v36 clamp
 v_max_f32 v132, s89, v132
 s_waitcnt lgkmcnt(6)
 v_mfma_f32_32x32x16_bf16 v[224:239], a[248:251], a[12:15], v[224:239]
 buffer_load_dwordx4 v5, s[40:43], s83 offen offset:1024 lds
 ds_read_b128 a[236:239], v14 offset:128
 v_exp_f32_e64 v37, v37 clamp
 v_max_f32 v133, s89, v133
 v_mfma_f32_32x32x16_bf16 v[240:255], a[252:255], a[12:15], v[240:255]
 ds_read_b64_tr_b16 a[240:241], v25 offset:61440
 ds_read_b64_tr_b16 a[242:243], v25 offset:61952
 v_exp_f32_e64 v38, v38 clamp
 v_max_f32 v134, s89, v134
 s_waitcnt lgkmcnt(5)
 v_mfma_f32_32x32x16_bf16 v[192:207], a[224:227], a[16:19], v[192:207]
 s_add_u32 m0, s81, 106496
 s_add_u32 s83, s83, 86016
 buffer_load_dwordx4 v4, s[36:39], s83 offen offset:0 lds
 ds_read_b64_tr_b16 a[244:245], v26 offset:61440
 ds_read_b64_tr_b16 a[246:247], v26 offset:61952
 v_mfma_f32_32x32x16_bf16 v[208:223], a[228:231], a[16:19], v[208:223]
 ds_read_b64_tr_b16 a[248:249], v27 offset:61440
 ds_read_b64_tr_b16 a[250:251], v27 offset:61952
 v_exp_f32_e64 v39, v39 clamp
 v_max_f32 v135, s89, v135
 s_waitcnt lgkmcnt(6)
 v_mfma_f32_32x32x16_bf16 v[224:239], a[232:235], a[16:19], v[224:239]
 buffer_load_dwordx4 v5, s[40:43], s83 offen offset:1024 lds
 ds_read_b128 a[252:255], v14 offset:160
 v_add_f32 v132, v132, v36
 v_add_f32 v133, v133, v37
 v_add_f32 v134, v134, v38
 v_add_f32 v135, v135, v39
 v_mfma_f32_32x32x16_bf16 v[240:255], a[236:239], a[16:19], v[240:255]
 ds_read_b64_tr_b16 a[224:225], v29 offset:0
 ds_read_b64_tr_b16 a[226:227], v29 offset:512
 v_fmamk_f32 v36, v136, 0x3fb8aa3b, v91
 v_fmamk_f32 v37, v137, 0x3fb8aa3b, v91
 v_fmamk_f32 v38, v138, 0x3fb8aa3b, v91
 s_waitcnt lgkmcnt(5)
 v_mfma_f32_32x32x16_bf16 v[192:207], a[240:243], a[20:23], v[192:207]
 s_add_u32 m0, s81, 0
 s_add_u32 s83, s83, 86016
 s_cmp_eq_u32 s83, 1204480
 s_cselect_b32 s83, 256, s83
 buffer_load_dwordx4 v4, s[36:39], s83 offen offset:0 lds
 ds_read_b64_tr_b16 a[228:229], v30 offset:0
 ds_read_b64_tr_b16 a[230:231], v30 offset:512
 v_mfma_f32_32x32x16_bf16 v[208:223], a[244:247], a[20:23], v[208:223]
 ds_read_b64_tr_b16 a[232:233], v31 offset:0
 ds_read_b64_tr_b16 a[234:235], v31 offset:512
 v_fmamk_f32 v39, v139, 0x3fb8aa3b, v91
 v_exp_f32_e64 v36, v36 clamp
 s_waitcnt lgkmcnt(6)
 v_mfma_f32_32x32x16_bf16 v[224:239], a[248:251], a[20:23], v[224:239]
 buffer_load_dwordx4 v5, s[40:43], s83 offen offset:1024 lds
 ds_read_b128 a[236:239], v14 offset:192
 v_max_f32 v136, s89, v136
 v_exp_f32_e64 v37, v37 clamp
 v_max_f32 v137, s89, v137
 v_mfma_f32_32x32x16_bf16 v[240:255], a[252:255], a[20:23], v[240:255]
 ds_read_b64_tr_b16 a[240:241], v29 offset:4096
 ds_read_b64_tr_b16 a[242:243], v29 offset:4608
 v_exp_f32_e64 v38, v38 clamp
 v_max_f32 v138, s89, v138
 s_waitcnt lgkmcnt(5)
 v_mfma_f32_32x32x16_bf16 v[192:207], a[224:227], a[24:27], v[192:207]
 s_add_u32 m0, s81, 8192
 s_add_u32 s83, s83, 86016
 buffer_load_dwordx4 v4, s[36:39], s83 offen offset:0 lds
 ds_read_b64_tr_b16 a[244:245], v30 offset:4096
 ds_read_b64_tr_b16 a[246:247], v30 offset:4608
 v_mfma_f32_32x32x16_bf16 v[208:223], a[228:231], a[24:27], v[208:223]
 ds_read_b64_tr_b16 a[248:249], v31 offset:4096
 ds_read_b64_tr_b16 a[250:251], v31 offset:4608
 v_exp_f32_e64 v39, v39 clamp
 v_max_f32 v139, s89, v139
 s_waitcnt lgkmcnt(6)
 v_mfma_f32_32x32x16_bf16 v[224:239], a[232:235], a[24:27], v[224:239]
 buffer_load_dwordx4 v5, s[40:43], s83 offen offset:1024 lds
 ds_read_b128 a[252:255], v14 offset:224
 v_add_f32 v136, v136, v36
 v_add_f32 v137, v137, v37
 v_add_f32 v138, v138, v38
 v_add_f32 v139, v139, v39
 v_mfma_f32_32x32x16_bf16 v[240:255], a[236:239], a[24:27], v[240:255]
 s_waitcnt vmcnt(16)
 s_barrier
 ds_read_b64_tr_b16 a[224:225], v21 offset:16384
 ds_read_b64_tr_b16 a[226:227], v21 offset:16896
 s_waitcnt lgkmcnt(5)
 v_mfma_f32_32x32x16_bf16 v[192:207], a[240:243], a[28:31], v[192:207]
 ds_read_b64_tr_b16 a[228:229], v22 offset:16384
 ds_read_b64_tr_b16 a[230:231], v22 offset:16896
 v_fmamk_f32 v36, v140, 0x3fb8aa3b, v91
 v_fmamk_f32 v37, v141, 0x3fb8aa3b, v91
 v_fmamk_f32 v38, v142, 0x3fb8aa3b, v91
 v_fmamk_f32 v39, v143, 0x3fb8aa3b, v91
 buffer_load_dword v68, v85, s[44:47], s99 offen sc1
 v_mfma_f32_32x32x16_bf16 v[208:223], a[244:247], a[28:31], v[208:223]
 ds_read_b64_tr_b16 a[232:233], v23 offset:16384
 ds_read_b64_tr_b16 a[234:235], v23 offset:16896
 v_exp_f32_e64 v36, v36 clamp
 v_max_f32 v140, s89, v140
 s_waitcnt lgkmcnt(6)
 v_mfma_f32_32x32x16_bf16 v[224:239], a[248:251], a[28:31], v[224:239]
 ds_read_b128 a[236:239], v14 offset:256
 v_exp_f32_e64 v37, v37 clamp
 v_max_f32 v141, s89, v141
 v_exp_f32_e64 v38, v38 clamp
 v_mfma_f32_32x32x16_bf16 v[240:255], a[252:255], a[28:31], v[240:255]
 ds_read_b64_tr_b16 a[240:241], v21 offset:20480
 ds_read_b64_tr_b16 a[242:243], v21 offset:20992
 v_max_f32 v142, s89, v142
 v_exp_f32_e64 v39, v39 clamp
 s_waitcnt lgkmcnt(5)
 v_mfma_f32_32x32x16_bf16 v[192:207], a[224:227], a[32:35], v[192:207]
 ds_read_b64_tr_b16 a[244:245], v22 offset:20480
 ds_read_b64_tr_b16 a[246:247], v22 offset:20992
 v_max_f32 v143, s89, v143
 v_add_f32 v140, v140, v36
 v_add_f32 v141, v141, v37
 v_add_f32 v142, v142, v38
 v_mfma_f32_32x32x16_bf16 v[208:223], a[228:231], a[32:35], v[208:223]
 ds_read_b64_tr_b16 a[248:249], v23 offset:20480
 ds_read_b64_tr_b16 a[250:251], v23 offset:20992
 v_add_f32 v143, v143, v39
 v_cvt_pk_bf16_f32 v128, v128, v129
 v_cvt_pk_bf16_f32 v129, v130, v131
 s_waitcnt lgkmcnt(6)
 v_mfma_f32_32x32x16_bf16 v[224:239], a[232:235], a[32:35], v[224:239]
 ds_read_b128 a[252:255], v14 offset:288
 v_cvt_pk_bf16_f32 v130, v132, v133
 v_cvt_pk_bf16_f32 v131, v134, v135
 v_cvt_pk_bf16_f32 v132, v136, v137
 v_cvt_pk_bf16_f32 v133, v138, v139
 v_cvt_pk_bf16_f32 v134, v140, v141
 v_mfma_f32_32x32x16_bf16 v[240:255], a[236:239], a[32:35], v[240:255]
 ds_read_b64_tr_b16 a[224:225], v21 offset:24576
 ds_read_b64_tr_b16 a[226:227], v21 offset:25088
 v_cvt_pk_bf16_f32 v135, v142, v143
 v_fmamk_f32 v36, v144, 0x3fb8aa3b, v91
 v_fmamk_f32 v37, v145, 0x3fb8aa3b, v91
 s_waitcnt lgkmcnt(5)
 v_mfma_f32_32x32x16_bf16 v[192:207], a[240:243], a[36:39], v[192:207]
 ds_read_b64_tr_b16 a[228:229], v22 offset:24576
 ds_read_b64_tr_b16 a[230:231], v22 offset:25088
 v_fmamk_f32 v38, v146, 0x3fb8aa3b, v91
 v_fmamk_f32 v39, v147, 0x3fb8aa3b, v91
 v_exp_f32_e64 v36, v36 clamp
 v_mfma_f32_32x32x16_bf16 v[208:223], a[244:247], a[36:39], v[208:223]
 ds_read_b64_tr_b16 a[232:233], v23 offset:24576
 ds_read_b64_tr_b16 a[234:235], v23 offset:25088
 v_max_f32 v144, s89, v144
 v_exp_f32_e64 v37, v37 clamp
 s_waitcnt lgkmcnt(6)
 v_mfma_f32_32x32x16_bf16 v[224:239], a[248:251], a[36:39], v[224:239]
 ds_read_b128 a[236:239], v14 offset:320
 v_max_f32 v145, s89, v145
 v_exp_f32_e64 v38, v38 clamp
 v_max_f32 v146, s89, v146
 v_mfma_f32_32x32x16_bf16 v[240:255], a[252:255], a[36:39], v[240:255]
 ds_read_b64_tr_b16 a[240:241], v21 offset:28672
 ds_read_b64_tr_b16 a[242:243], v21 offset:29184
 v_exp_f32_e64 v39, v39 clamp
 v_max_f32 v147, s89, v147
 s_waitcnt lgkmcnt(5)
 v_mfma_f32_32x32x16_bf16 v[192:207], a[224:227], a[40:43], v[192:207]
 ds_read_b64_tr_b16 a[244:245], v22 offset:28672
 ds_read_b64_tr_b16 a[246:247], v22 offset:29184
 v_add_f32 v144, v144, v36
 v_add_f32 v145, v145, v37
 v_add_f32 v146, v146, v38
 v_add_f32 v147, v147, v39
 v_mfma_f32_32x32x16_bf16 v[208:223], a[228:231], a[40:43], v[208:223]
 ds_read_b64_tr_b16 a[248:249], v23 offset:28672
 ds_read_b64_tr_b16 a[250:251], v23 offset:29184
 v_fmamk_f32 v36, v148, 0x3fb8aa3b, v91
 v_fmamk_f32 v37, v149, 0x3fb8aa3b, v91
 v_fmamk_f32 v38, v150, 0x3fb8aa3b, v91
 s_waitcnt lgkmcnt(6)
 v_mfma_f32_32x32x16_bf16 v[224:239], a[232:235], a[40:43], v[224:239]
 ds_read_b128 a[252:255], v14 offset:352
 v_fmamk_f32 v39, v151, 0x3fb8aa3b, v91
 v_exp_f32_e64 v36, v36 clamp
 v_max_f32 v148, s89, v148
 s_waitcnt vmcnt(0)
 v_cmp_lt_u32 vcc, 0, v68
 s_nop 0
 s_cmp_eq_u64 vcc, -1
 s_cbranch_scc0 L_spin_P
L_ok_P:
 buffer_load_dwordx4 a[112:115], v63, s[44:47], 0 offen offset:0 sc1
 buffer_load_dwordx4 a[116:119], v84, s[44:47], 0 offen offset:0 sc1
 buffer_load_dwordx4 a[120:123], v63, s[44:47], 0 offen offset:256 sc1
 buffer_load_dwordx4 a[124:127], v84, s[44:47], 0 offen offset:256 sc1
 buffer_load_dwordx4 a[128:131], v63, s[44:47], 0 offen offset:512 sc1
 buffer_load_dwordx4 a[132:135], v84, s[44:47], 0 offen offset:512 sc1
 buffer_load_dwordx4 a[136:139], v63, s[44:47], 0 offen offset:768 sc1
 v_mfma_f32_32x32x16_bf16 v[240:255], a[236:239], a[40:43], v[240:255]
 s_barrier
 ds_read_b64_tr_b16 a[224:225], v29 offset:8192
 ds_read_b64_tr_b16 a[226:227], v29 offset:8704
 s_waitcnt lgkmcnt(5)
 v_mfma_f32_32x32x16_bf16 v[192:207], a[240:243], a[44:47], v[192:207]
 ds_read_b64_tr_b16 a[228:229], v30 offset:8192
 ds_read_b64_tr_b16 a[230:231], v30 offset:8704
 v_exp_f32_e64 v37, v37 clamp
 v_max_f32 v149, s89, v149
 v_mfma_f32_32x32x16_bf16 v[208:223], a[244:247], a[44:47], v[208:223]
 buffer_load_dwordx4 a[140:143], v84, s[44:47], 0 offen offset:768 sc1
 ds_read_b64_tr_b16 a[232:233], v31 offset:8192
 ds_read_b64_tr_b16 a[234:235], v31 offset:8704
 v_exp_f32_e64 v38, v38 clamp
 s_waitcnt lgkmcnt(6)
 v_mfma_f32_32x32x16_bf16 v[224:239], a[248:251], a[44:47], v[224:239]
 ds_read_b128 a[236:239], v14 offset:384
 v_max_f32 v150, s89, v150
 v_exp_f32_e64 v39, v39 clamp
 v_max_f32 v151, s89, v151
 v_add_f32 v148, v148, v36
 v_mfma_f32_32x32x16_bf16 v[240:255], a[252:255], a[44:47], v[240:255]
 buffer_load_dwordx4 a[144:147], v63, s[44:47], 0 offen offset:1024 sc1
 ds_read_b64_tr_b16 a[240:241], v29 offset:12288
 ds_read_b64_tr_b16 a[242:243], v29 offset:12800
 v_add_f32 v149, v149, v37
 v_add_f32 v150, v150, v38
 s_waitcnt lgkmcnt(5)
 v_mfma_f32_32x32x16_bf16 v[192:207], a[224:227], a[48:51], v[192:207]
 ds_read_b64_tr_b16 a[244:245], v30 offset:12288
 ds_read_b64_tr_b16 a[246:247], v30 offset:12800
 v_add_f32 v151, v151, v39
 v_fmamk_f32 v36, v152, 0x3fb8aa3b, v91
 v_fmamk_f32 v37, v153, 0x3fb8aa3b, v91
 v_fmamk_f32 v38, v154, 0x3fb8aa3b, v91
 v_mfma_f32_32x32x16_bf16 v[208:223], a[228:231], a[48:51], v[208:223]
 buffer_load_dwordx4 a[148:151], v84, s[44:47], 0 offen offset:1024 sc1
 ds_read_b64_tr_b16 a[248:249], v31 offset:12288
 ds_read_b64_tr_b16 a[250:251], v31 offset:12800
 v_fmamk_f32 v39, v155, 0x3fb8aa3b, v91
 s_waitcnt vmcnt(8)
 v_mfma_f32_32x32x16_bf16 v[96:111], a[112:115], a[116:119], 0
 v_exp_f32_e64 v36, v36 clamp
 v_max_f32 v152, s89, v152
 v_exp_f32_e64 v37, v37 clamp
 v_max_f32 v153, s89, v153
 v_mfma_f32_32x32x16_bf16 v[112:127], a[112:115], v[92:95], 0
 buffer_load_dwordx4 a[152:155], v63, s[44:47], 0 offen offset:1280 sc1
 v_exp_f32_e64 v38, v38 clamp
 v_max_f32 v154, s89, v154
 v_exp_f32_e64 v39, v39 clamp
 s_waitcnt lgkmcnt(6)
 v_mfma_f32_32x32x16_bf16 v[224:239], a[232:235], a[48:51], v[224:239]
 ds_read_b128 a[252:255], v14 offset:416
 v_max_f32 v155, s89, v155
 v_add_f32 v152, v152, v36
 v_add_f32 v153, v153, v37
 v_add_f32 v154, v154, v38
 v_add_f32 v155, v155, v39
 v_mfma_f32_32x32x16_bf16 v[240:255], a[236:239], a[48:51], v[240:255]
 buffer_load_dwordx4 a[156:159], v84, s[44:47], 0 offen offset:1280 sc1
 ds_read_b64_tr_b16 a[224:225], v29 offset:16384
 ds_read_b64_tr_b16 a[226:227], v29 offset:16896
 v_fmamk_f32 v36, v156, 0x3fb8aa3b, v91
 v_fmamk_f32 v37, v157, 0x3fb8aa3b, v91
 s_waitcnt vmcnt(8)
 v_mfma_f32_32x32x16_bf16 v[96:111], a[120:123], a[124:127], v[96:111]
 v_fmamk_f32 v38, v158, 0x3fb8aa3b, v91
 v_fmamk_f32 v39, v159, 0x3fb8aa3b, v91
 v_exp_f32_e64 v36, v36 clamp
 v_max_f32 v156, s89, v156
 v_mfma_f32_32x32x16_bf16 v[112:127], a[120:123], v[92:95], v[112:127]
 buffer_load_dwordx4 a[160:163], v63, s[44:47], 0 offen offset:1536 sc1
 v_exp_f32_e64 v37, v37 clamp
 v_max_f32 v157, s89, v157
 v_exp_f32_e64 v38, v38 clamp
 s_waitcnt lgkmcnt(5)
 v_mfma_f32_32x32x16_bf16 v[192:207], a[240:243], a[52:55], v[192:207]
 ds_read_b64_tr_b16 a[228:229], v30 offset:16384
 ds_read_b64_tr_b16 a[230:231], v30 offset:16896
 v_max_f32 v158, s89, v158
 v_exp_f32_e64 v39, v39 clamp
 v_max_f32 v159, s89, v159
 v_mfma_f32_32x32x16_bf16 v[208:223], a[244:247], a[52:55], v[208:223]
 buffer_load_dwordx4 a[164:167], v84, s[44:47], 0 offen offset:1536 sc1
 ds_read_b64_tr_b16 a[232:233], v31 offset:16384
 ds_read_b64_tr_b16 a[234:235], v31 offset:16896
 v_add_f32 v156, v156, v36
 v_add_f32 v157, v157, v37
 s_waitcnt vmcnt(8)
 v_mfma_f32_32x32x16_bf16 v[96:111], a[128:131], a[132:135], v[96:111]
 v_add_f32 v158, v158, v38
 v_add_f32 v159, v159, v39
 v_cvt_pk_bf16_f32 v136, v144, v145
 v_cvt_pk_bf16_f32 v137, v146, v147
 v_cvt_pk_bf16_f32 v138, v148, v149
 v_cvt_pk_bf16_f32 v139, v150, v151
 v_mfma_f32_32x32x16_bf16 v[112:127], a[128:131], v[92:95], v[112:127]
 buffer_load_dwordx4 a[168:171], v63, s[44:47], 0 offen offset:1792 sc1
 v_cvt_pk_bf16_f32 v140, v152, v153
 v_cvt_pk_bf16_f32 v141, v154, v155
 v_cvt_pk_bf16_f32 v142, v156, v157
 v_cvt_pk_bf16_f32 v143, v158, v159
 v_fmamk_f32 v36, v160, 0x3fb8aa3b, v91
 s_waitcnt lgkmcnt(6)
 v_mfma_f32_32x32x16_bf16 v[224:239], a[248:251], a[52:55], v[224:239]
 ds_read_b128 a[236:239], v14 offset:448
 v_fmamk_f32 v37, v161, 0x3fb8aa3b, v91
 v_fmamk_f32 v38, v162, 0x3fb8aa3b, v91
 v_fmamk_f32 v39, v163, 0x3fb8aa3b, v91
 v_exp_f32_e64 v36, v36 clamp
 v_mfma_f32_32x32x16_bf16 v[240:255], a[252:255], a[52:55], v[240:255]
 buffer_load_dwordx4 a[172:175], v84, s[44:47], 0 offen offset:1792 sc1
 ds_read_b64_tr_b16 a[240:241], v29 offset:20480
 ds_read_b64_tr_b16 a[242:243], v29 offset:20992
 v_max_f32 v160, s89, v160
 s_waitcnt vmcnt(8)
 v_mfma_f32_32x32x16_bf16 v[96:111], a[136:139], a[140:143], v[96:111]
 v_exp_f32_e64 v37, v37 clamp
 v_max_f32 v161, s89, v161
 v_exp_f32_e64 v38, v38 clamp
 v_max_f32 v162, s89, v162
 v_mfma_f32_32x32x16_bf16 v[112:127], a[136:139], v[92:95], v[112:127]
 buffer_load_dwordx4 a[176:179], v63, s[44:47], 0 offen offset:2048 sc1
 v_exp_f32_e64 v39, v39 clamp
 v_max_f32 v163, s89, v163
 v_add_f32 v160, v160, v36
 v_add_f32 v161, v161, v37
 s_waitcnt lgkmcnt(5)
 v_mfma_f32_32x32x16_bf16 v[192:207], a[224:227], a[56:59], v[192:207]
 ds_read_b64_tr_b16 a[244:245], v30 offset:20480
 ds_read_b64_tr_b16 a[246:247], v30 offset:20992
 v_add_f32 v162, v162, v38
 v_add_f32 v163, v163, v39
 v_fmamk_f32 v36, v164, 0x3fb8aa3b, v91
 v_fmamk_f32 v37, v165, 0x3fb8aa3b, v91
 v_mfma_f32_32x32x16_bf16 v[208:223], a[228:231], a[56:59], v[208:223]
 buffer_load_dwordx4 a[180:183], v84, s[44:47], 0 offen offset:2048 sc1
 ds_read_b64_tr_b16 a[248:249], v31 offset:20480
 ds_read_b64_tr_b16 a[250:251], v31 offset:20992
 v_fmamk_f32 v38, v166, 0x3fb8aa3b, v91
 v_fmamk_f32 v39, v167, 0x3fb8aa3b, v91
 s_waitcnt vmcnt(8)
 v_mfma_f32_32x32x16_bf16 v[96:111], a[144:147], a[148:151], v[96:111]
 v_exp_f32_e64 v36, v36 clamp
 v_max_f32 v164, s89, v164
 v_exp_f32_e64 v37, v37 clamp
 v_max_f32 v165, s89, v165
 v_mfma_f32_32x32x16_bf16 v[112:127], a[144:147], v[92:95], v[112:127]
 buffer_load_dwordx4 a[184:187], v63, s[44:47], 0 offen offset:2304 sc1
 v_exp_f32_e64 v38, v38 clamp
 v_max_f32 v166, s89, v166
 v_exp_f32_e64 v39, v39 clamp
 s_waitcnt lgkmcnt(6)
 v_mfma_f32_32x32x16_bf16 v[224:239], a[232:235], a[56:59], v[224:239]
 ds_read_b128 a[252:255], v14 offset:480
 v_max_f32 v167, s89, v167
 v_add_f32 v164, v164, v36
 v_add_f32 v165, v165, v37
 v_add_f32 v166, v166, v38
 v_add_f32 v167, v167, v39
 v_mfma_f32_32x32x16_bf16 v[240:255], a[236:239], a[56:59], v[240:255]
 buffer_load_dwordx4 a[188:191], v84, s[44:47], 0 offen offset:2304 sc1
 s_barrier
 ds_read_b64_tr_b16 a[224:225], v21 offset:32768
 ds_read_b64_tr_b16 a[226:227], v21 offset:33280
 s_waitcnt vmcnt(8)
 v_mfma_f32_32x32x16_bf16 v[96:111], a[152:155], a[156:159], v[96:111]
 v_fmamk_f32 v36, v168, 0x3fb8aa3b, v91
 v_fmamk_f32 v37, v169, 0x3fb8aa3b, v91
 v_fmamk_f32 v38, v170, 0x3fb8aa3b, v91
 v_fmamk_f32 v39, v171, 0x3fb8aa3b, v91
 v_exp_f32_e64 v36, v36 clamp
 v_mfma_f32_32x32x16_bf16 v[112:127], a[152:155], v[92:95], v[112:127]
 buffer_load_dwordx4 a[192:195], v63, s[44:47], 0 offen offset:2560 sc1
 v_max_f32 v168, s89, v168
 v_exp_f32_e64 v37, v37 clamp
 v_max_f32 v169, s89, v169
 s_waitcnt lgkmcnt(5)
 v_mfma_f32_32x32x16_bf16 v[192:207], a[240:243], a[60:63], v[192:207]
 ds_read_b64_tr_b16 a[228:229], v22 offset:32768
 ds_read_b64_tr_b16 a[230:231], v22 offset:33280
 v_exp_f32_e64 v38, v38 clamp
 v_max_f32 v170, s89, v170
 v_mfma_f32_32x32x16_bf16 v[208:223], a[244:247], a[60:63], v[208:223]
 buffer_load_dwordx4 a[196:199], v84, s[44:47], 0 offen offset:2560 sc1
 ds_read_b64_tr_b16 a[232:233], v23 offset:32768
 ds_read_b64_tr_b16 a[234:235], v23 offset:33280
 v_exp_f32_e64 v39, v39 clamp
 s_waitcnt vmcnt(8)
 v_mfma_f32_32x32x16_bf16 v[96:111], a[160:163], a[164:167], v[96:111]
 v_max_f32 v171, s89, v171
 v_add_f32 v168, v168, v36
 v_add_f32 v169, v169, v37
 v_add_f32 v170, v170, v38
 v_add_f32 v171, v171, v39
 v_fmamk_f32 v36, v172, 0x3fb8aa3b, v91
 v_mfma_f32_32x32x16_bf16 v[112:127], a[160:163], v[92:95], v[112:127]
 buffer_load_dwordx4 a[200:203], v63, s[44:47], 0 offen offset:2816 sc1
 v_fmamk_f32 v37, v173, 0x3fb8aa3b, v91
 v_fmamk_f32 v38, v174, 0x3fb8aa3b, v91
 v_fmamk_f32 v39, v175, 0x3fb8aa3b, v91
 v_exp_f32_e64 v36, v36 clamp
 s_waitcnt lgkmcnt(6)
 v_mfma_f32_32x32x16_bf16 v[224:239], a[248:251], a[60:63], v[224:239]
 ds_read_b128 a[236:239], v14 offset:512
 v_max_f32 v172, s89, v172
 v_exp_f32_e64 v37, v37 clamp
 v_max_f32 v173, s89, v173
 v_mfma_f32_32x32x16_bf16 v[240:255], a[252:255], a[60:63], v[240:255]
 buffer_load_dwordx4 a[204:207], v84, s[44:47], 0 offen offset:2816 sc1
 ds_read_b64_tr_b16 a[240:241], v21 offset:36864
 ds_read_b64_tr_b16 a[242:243], v21 offset:37376
 v_exp_f32_e64 v38, v38 clamp
 s_waitcnt vmcnt(8)
 v_mfma_f32_32x32x16_bf16 v[96:111], a[168:171], a[172:175], v[96:111]
 v_max_f32 v174, s89, v174
 v_exp_f32_e64 v39, v39 clamp
 v_max_f32 v175, s89, v175
 v_add_f32 v172, v172, v36
 v_add_f32 v173, v173, v37
 v_mfma_f32_32x32x16_bf16 v[112:127], a[168:171], v[92:95], v[112:127]
 buffer_load_dwordx4 a[208:211], v63, s[44:47], 0 offen offset:3072 sc1
 v_add_f32 v174, v174, v38
 v_add_f32 v175, v175, v39
 v_cvt_pk_bf16_f32 v144, v160, v161
 v_cvt_pk_bf16_f32 v145, v162, v163
 v_cvt_pk_bf16_f32 v146, v164, v165
 s_waitcnt lgkmcnt(5)
 v_mfma_f32_32x32x16_bf16 v[192:207], a[224:227], a[64:67], v[192:207]
 ds_read_b64_tr_b16 a[244:245], v22 offset:36864
 ds_read_b64_tr_b16 a[246:247], v22 offset:37376
 v_cvt_pk_bf16_f32 v147, v166, v167
 v_cvt_pk_bf16_f32 v148, v168, v169
 v_cvt_pk_bf16_f32 v149, v170, v171
 v_cvt_pk_bf16_f32 v150, v172, v173
 v_mfma_f32_32x32x16_bf16 v[208:223], a[228:231], a[64:67], v[208:223]
 buffer_load_dwordx4 a[212:215], v84, s[44:47], 0 offen offset:3072 sc1
 ds_read_b64_tr_b16 a[248:249], v23 offset:36864
 ds_read_b64_tr_b16 a[250:251], v23 offset:37376
 v_cvt_pk_bf16_f32 v151, v174, v175
 v_fmamk_f32 v36, v176, 0x3fb8aa3b, v91
 s_waitcnt vmcnt(8)
 v_mfma_f32_32x32x16_bf16 v[96:111], a[176:179], a[180:183], v[96:111]
 v_fmamk_f32 v37, v177, 0x3fb8aa3b, v91
 v_fmamk_f32 v38, v178, 0x3fb8aa3b, v91
 v_fmamk_f32 v39, v179, 0x3fb8aa3b, v91
 v_exp_f32_e64 v36, v36 clamp
 v_max_f32 v176, s89, v176
 v_mfma_f32_32x32x16_bf16 v[112:127], a[176:179], v[92:95], v[112:127]
 buffer_load_dwordx4 a[216:219], v63, s[44:47], 0 offen offset:3328 sc1
 v_exp_f32_e64 v37, v37 clamp
 v_max_f32 v177, s89, v177
 v_exp_f32_e64 v38, v38 clamp
 s_waitcnt lgkmcnt(6)
 v_mfma_f32_32x32x16_bf16 v[224:239], a[232:235], a[64:67], v[224:239]
 ds_read_b128 a[252:255], v14 offset:544
 v_max_f32 v178, s89, v178
 v_exp_f32_e64 v39, v39 clamp
 v_max_f32 v179, s89, v179
 v_add_f32 v176, v176, v36
 v_mfma_f32_32x32x16_bf16 v[240:255], a[236:239], a[64:67], v[240:255]
 buffer_load_dwordx4 a[220:223], v84, s[44:47], 0 offen offset:3328 sc1
 ds_read_b64_tr_b16 a[224:225], v21 offset:40960
 ds_read_b64_tr_b16 a[226:227], v21 offset:41472
 v_add_f32 v177, v177, v37
 v_add_f32 v178, v178, v38
 s_waitcnt vmcnt(8)
 v_mfma_f32_32x32x16_bf16 v[96:111], a[184:187], a[188:191], v[96:111]
 v_add_f32 v179, v179, v39
 v_fmamk_f32 v36, v180, 0x3fb8aa3b, v91
 v_fmamk_f32 v37, v181, 0x3fb8aa3b, v91
 v_fmamk_f32 v38, v182, 0x3fb8aa3b, v91
 v_fmamk_f32 v39, v183, 0x3fb8aa3b, v91
 v_mfma_f32_32x32x16_bf16 v[112:127], a[184:187], v[92:95], v[112:127]
 buffer_load_dwordx4 a[0:3], v63, s[44:47], 0 offen offset:3584 sc1
 v_exp_f32_e64 v36, v36 clamp
 v_max_f32 v180, s89, v180
 v_exp_f32_e64 v37, v37 clamp
 s_waitcnt lgkmcnt(5)
 v_mfma_f32_32x32x16_bf16 v[192:207], a[240:243], a[68:71], v[192:207]
 ds_read_b64_tr_b16 a[228:229], v22 offset:40960
 ds_read_b64_tr_b16 a[230:231], v22 offset:41472
 v_max_f32 v181, s89, v181
 v_exp_f32_e64 v38, v38 clamp
 v_max_f32 v182, s89, v182
 v_mfma_f32_32x32x16_bf16 v[208:223], a[244:247], a[68:71], v[208:223]
 buffer_load_dwordx4 a[4:7], v84, s[44:47], 0 offen offset:3584 sc1
 ds_read_b64_tr_b16 a[232:233], v23 offset:40960
 ds_read_b64_tr_b16 a[234:235], v23 offset:41472
 v_exp_f32_e64 v39, v39 clamp
 s_waitcnt vmcnt(8)
 v_mfma_f32_32x32x16_bf16 v[96:111], a[192:195], a[196:199], v[96:111]
 v_max_f32 v183, s89, v183
 v_add_f32 v180, v180, v36
 v_add_f32 v181, v181, v37
 v_add_f32 v182, v182, v38
 v_add_f32 v183, v183, v39
 v_fmamk_f32 v36, v184, 0x3fb8aa3b, v91
 v_mfma_f32_32x32x16_bf16 v[112:127], a[192:195], v[92:95], v[112:127]
 buffer_load_dwordx4 a[8:11], v63, s[44:47], 0 offen offset:3840 sc1
 v_fmamk_f32 v37, v185, 0x3fb8aa3b, v91
 v_fmamk_f32 v38, v186, 0x3fb8aa3b, v91
 v_fmamk_f32 v39, v187, 0x3fb8aa3b, v91
 v_exp_f32_e64 v36, v36 clamp
 s_waitcnt lgkmcnt(6)
 v_mfma_f32_32x32x16_bf16 v[224:239], a[248:251], a[68:71], v[224:239]
 ds_read_b128 a[236:239], v14 offset:576
 v_max_f32 v184, s89, v184
 v_exp_f32_e64 v37, v37 clamp
 v_max_f32 v185, s89, v185
 v_mfma_f32_32x32x16_bf16 v[240:255], a[252:255], a[68:71], v[240:255]
 buffer_load_dwordx4 a[12:15], v84, s[44:47], 0 offen offset:3840 sc1
 ds_read_b64_tr_b16 a[240:241], v21 offset:45056
 ds_read_b64_tr_b16 a[242:243], v21 offset:45568
 v_exp_f32_e64 v38, v38 clamp
 s_waitcnt vmcnt(8)
 v_mfma_f32_32x32x16_bf16 v[96:111], a[200:203], a[204:207], v[96:111]
 v_max_f32 v186, s89, v186
 v_exp_f32_e64 v39, v39 clamp
 v_max_f32 v187, s89, v187
 v_add_f32 v184, v184, v36
 v_add_f32 v185, v185, v37
 v_mfma_f32_32x32x16_bf16 v[112:127], a[200:203], v[92:95], v[112:127]
 v_add_f32 v186, v186, v38
 v_add_f32 v187, v187, v39
 v_fmamk_f32 v36, v188, 0x3fb8aa3b, v91
 v_fmamk_f32 v37, v189, 0x3fb8aa3b, v91
 v_fmamk_f32 v38, v190, 0x3fb8aa3b, v91
 v_fmamk_f32 v39, v191, 0x3fb8aa3b, v91
 s_waitcnt lgkmcnt(5)
 v_mfma_f32_32x32x16_bf16 v[192:207], a[224:227], a[72:75], v[192:207]
 ds_read_b64_tr_b16 a[244:245], v22 offset:45056
 ds_read_b64_tr_b16 a[246:247], v22 offset:45568
 v_exp_f32_e64 v36, v36 clamp
 v_max_f32 v188, s89, v188
 s_waitcnt vmcnt(6)
 v_mfma_f32_32x32x16_bf16 v[96:111], a[208:211], a[212:215], v[96:111]
 v_exp_f32_e64 v37, v37 clamp
 v_max_f32 v189, s89, v189
 v_exp_f32_e64 v38, v38 clamp
 v_max_f32 v190, s89, v190
 v_mfma_f32_32x32x16_bf16 v[112:127], a[208:211], v[92:95], v[112:127]
 v_exp_f32_e64 v39, v39 clamp
 v_max_f32 v191, s89, v191
 v_add_f32 v188, v188, v36
 v_add_f32 v189, v189, v37
 v_add_f32 v190, v190, v38
 v_mfma_f32_32x32x16_bf16 v[208:223], a[228:231], a[72:75], v[208:223]
 ds_read_b64_tr_b16 a[248:249], v23 offset:45056
 ds_read_b64_tr_b16 a[250:251], v23 offset:45568
 v_add_f32 v191, v191, v39
 v_cvt_pk_bf16_f32 v152, v176, v177
 v_cvt_pk_bf16_f32 v153, v178, v179
 s_waitcnt vmcnt(4)
 v_mfma_f32_32x32x16_bf16 v[96:111], a[216:219], a[220:223], v[96:111]
 v_cvt_pk_bf16_f32 v154, v180, v181
 v_cvt_pk_bf16_f32 v155, v182, v183
 v_cvt_pk_bf16_f32 v156, v184, v185
 v_cvt_pk_bf16_f32 v157, v186, v187
 v_cvt_pk_bf16_f32 v158, v188, v189
 v_cvt_pk_bf16_f32 v159, v190, v191
 v_mfma_f32_32x32x16_bf16 v[112:127], a[216:219], v[92:95], v[112:127]
 s_waitcnt lgkmcnt(6)
 v_mfma_f32_32x32x16_bf16 v[224:239], a[232:235], a[72:75], v[224:239]
 ds_read_b128 a[252:255], v14 offset:608
 s_waitcnt vmcnt(2)
 v_mfma_f32_32x32x16_bf16 v[96:111], a[0:3], a[4:7], v[96:111]
 v_mfma_f32_32x32x16_bf16 v[112:127], a[0:3], v[92:95], v[112:127]
 v_mfma_f32_32x32x16_bf16 v[240:255], a[236:239], a[72:75], v[240:255]
 s_barrier
 ds_read_b64_tr_b16 a[224:225], v29 offset:24576
 ds_read_b64_tr_b16 a[226:227], v29 offset:25088
 s_waitcnt vmcnt(0)
 v_mfma_f32_32x32x16_bf16 v[96:111], a[8:11], a[12:15], v[96:111]
 v_mfma_f32_32x32x16_bf16 v[112:127], a[8:11], v[92:95], v[112:127]
 s_waitcnt lgkmcnt(5)
 v_mfma_f32_32x32x16_bf16 v[192:207], a[240:243], a[76:79], v[192:207]
 ds_read_b64_tr_b16 a[228:229], v30 offset:24576
 ds_read_b64_tr_b16 a[230:231], v30 offset:25088
 s_nop 7
 v_cndmask_b32_e64 v96, v96, v112, s[92:93]
 v_cndmask_b32_e64 v97, v97, v113, s[92:93]
 v_cndmask_b32_e64 v98, v98, v114, s[92:93]
 v_cndmask_b32_e64 v99, v99, v115, s[92:93]
 ds_write_b128 v87, v[96:99] offset:0
 v_cndmask_b32_e64 v100, v100, v116, s[92:93]
 v_cndmask_b32_e64 v101, v101, v117, s[92:93]
 v_cndmask_b32_e64 v102, v102, v118, s[92:93]
 v_cndmask_b32_e64 v103, v103, v119, s[92:93]
 ds_write_b128 v87, v[100:103] offset:1024
 v_cndmask_b32_e64 v104, v104, v120, s[92:93]
 v_cndmask_b32_e64 v105, v105, v121, s[92:93]
 v_cndmask_b32_e64 v106, v106, v122, s[92:93]
 v_cndmask_b32_e64 v107, v107, v123, s[92:93]
 ds_write_b128 v87, v[104:107] offset:2048
 v_cndmask_b32_e64 v108, v108, v124, s[92:93]
 v_cndmask_b32_e64 v109, v109, v125, s[92:93]
 v_cndmask_b32_e64 v110, v110, v126, s[92:93]
 v_cndmask_b32_e64 v111, v111, v127, s[92:93]
 ds_write_b128 v87, v[108:111] offset:3072
 s_waitcnt lgkmcnt(0)
 s_barrier
 ds_read_b128 v[112:115], v88 offset:0
 ds_read_b128 v[116:119], v88 offset:4096
 ds_read_b128 v[120:123], v88 offset:8192
 ds_read_b128 v[124:127], v88 offset:12288
 s_waitcnt lgkmcnt(0)
 v_pk_add_f32 v[112:113], v[112:113], v[116:117]
 v_pk_add_f32 v[114:115], v[114:115], v[118:119]
 v_pk_add_f32 v[120:121], v[120:121], v[124:125]
 v_pk_add_f32 v[122:123], v[122:123], v[126:127]
 v_pk_add_f32 v[112:113], v[112:113], v[120:121]
 v_pk_add_f32 v[114:115], v[114:115], v[122:123]
 v_cvt_pk_bf16_f32 v116, v112, v113
 v_cvt_pk_bf16_f32 v117, v114, v115
 v_cndmask_b32_e64 v116, v116, v62, s[56:57]
 v_cndmask_b32_e64 v117, v117, v62, s[56:57]
 buffer_store_dwordx2 v[116:117], v90, s[44:47], s54 offen sc1
 v_mfma_f32_32x32x16_bf16 v[208:223], a[244:247], a[76:79], v[208:223]
 ds_read_b64_tr_b16 a[232:233], v31 offset:24576
 ds_read_b64_tr_b16 a[234:235], v31 offset:25088
 v_mfma_f32_32x32x16_bf16 v[224:239], a[248:251], a[76:79], v[224:239]
 ds_read_b128 a[236:239], v14 offset:640
 v_mfma_f32_32x32x16_bf16 v[240:255], a[252:255], a[76:79], v[240:255]
 ds_read_b64_tr_b16 a[240:241], v29 offset:28672
 ds_read_b64_tr_b16 a[242:243], v29 offset:29184
 v_mfma_f32_32x32x16_bf16 v[192:207], a[224:227], a[80:83], v[192:207]
 ds_read_b64_tr_b16 a[244:245], v30 offset:28672
 ds_read_b64_tr_b16 a[246:247], v30 offset:29184
 v_mfma_f32_32x32x16_bf16 v[208:223], a[228:231], a[80:83], v[208:223]
 ds_read_b64_tr_b16 a[248:249], v31 offset:28672
 ds_read_b64_tr_b16 a[250:251], v31 offset:29184
 s_waitcnt lgkmcnt(6)
 v_mfma_f32_32x32x16_bf16 v[224:239], a[232:235], a[80:83], v[224:239]
 ds_read_b128 a[252:255], v14 offset:672
 v_mfma_f32_32x32x16_bf16 v[240:255], a[236:239], a[80:83], v[240:255]
 ds_read_b64_tr_b16 a[224:225], v25 offset:40960
 ds_read_b64_tr_b16 a[226:227], v25 offset:41472
 s_waitcnt lgkmcnt(5)
 v_mfma_f32_32x32x16_bf16 v[192:207], a[240:243], a[84:87], v[192:207]
 ds_read_b64_tr_b16 a[228:229], v26 offset:40960
 ds_read_b64_tr_b16 a[230:231], v26 offset:41472
 v_mfma_f32_32x32x16_bf16 v[208:223], a[244:247], a[84:87], v[208:223]
 ds_read_b64_tr_b16 a[232:233], v27 offset:40960
 ds_read_b64_tr_b16 a[234:235], v27 offset:41472
 s_waitcnt lgkmcnt(6)
 v_mfma_f32_32x32x16_bf16 v[224:239], a[248:251], a[84:87], v[224:239]
 ds_read_b128 a[236:239], v14 offset:704
 v_mfma_f32_32x32x16_bf16 v[240:255], a[252:255], a[84:87], v[240:255]
 ds_read_b64_tr_b16 a[240:241], v25 offset:45056
 ds_read_b64_tr_b16 a[242:243], v25 offset:45568
 s_waitcnt lgkmcnt(5)
 v_mfma_f32_32x32x16_bf16 v[192:207], a[224:227], a[88:91], v[192:207]
 ds_read_b64_tr_b16 a[244:245], v26 offset:45056
 ds_read_b64_tr_b16 a[246:247], v26 offset:45568
 s_waitcnt vmcnt(0)
 buffer_store_dword v12, v33, s[44:47], s10 offen sc1
 v_mfma_f32_32x32x16_bf16 v[208:223], a[228:231], a[88:91], v[208:223]
 ds_read_b64_tr_b16 a[248:249], v27 offset:45056
 ds_read_b64_tr_b16 a[250:251], v27 offset:45568
 s_waitcnt lgkmcnt(6)
 v_mfma_f32_32x32x16_bf16 v[224:239], a[232:235], a[88:91], v[224:239]
 ds_read_b128 a[252:255], v14 offset:736
 v_mfma_f32_32x32x16_bf16 v[240:255], a[236:239], a[88:91], v[240:255]
 s_barrier
 ds_read_b64_tr_b16 a[224:225], v21 offset:0
 ds_read_b64_tr_b16 a[226:227], v21 offset:512
 s_waitcnt lgkmcnt(5)
 v_mfma_f32_32x32x16_bf16 v[192:207], a[240:243], a[92:95], v[192:207]
 ds_read_b64_tr_b16 a[228:229], v22 offset:0
 ds_read_b64_tr_b16 a[230:231], v22 offset:512
 v_mfma_f32_32x32x16_bf16 v[208:223], a[244:247], a[92:95], v[208:223]
 ds_read_b64_tr_b16 a[232:233], v23 offset:0
 ds_read_b64_tr_b16 a[234:235], v23 offset:512
 s_waitcnt lgkmcnt(6)
 v_mfma_f32_32x32x16_bf16 v[224:239], a[248:251], a[92:95], v[224:239]
 ds_read_b128 a[236:239], v14 offset:768
 v_mfma_f32_32x32x16_bf16 v[240:255], a[252:255], a[92:95], v[240:255]
 ds_read_b64_tr_b16 a[240:241], v21 offset:4096
 ds_read_b64_tr_b16 a[242:243], v21 offset:4608
 s_waitcnt lgkmcnt(5)
 v_mfma_f32_32x32x16_bf16 v[192:207], a[224:227], a[96:99], v[192:207]
 ds_read_b64_tr_b16 a[244:245], v22 offset:4096
 ds_read_b64_tr_b16 a[246:247], v22 offset:4608
 v_mfma_f32_32x32x16_bf16 v[208:223], a[228:231], a[96:99], v[208:223]
 ds_read_b64_tr_b16 a[248:249], v23 offset:4096
 ds_read_b64_tr_b16 a[250:251], v23 offset:4608
 s_waitcnt lgkmcnt(6)
 v_mfma_f32_32x32x16_bf16 v[224:239], a[232:235], a[96:99], v[224:239]
 ds_read_b128 a[252:255], v14 offset:800
 v_mfma_f32_32x32x16_bf16 v[240:255], a[236:239], a[96:99], v[240:255]
 ds_read_b64_tr_b16 a[224:225], v21 offset:8192
 ds_read_b64_tr_b16 a[226:227], v21 offset:8704
 s_waitcnt lgkmcnt(5)
 v_mfma_f32_32x32x16_bf16 v[192:207], a[240:243], a[100:103], v[192:207]
 ds_read_b64_tr_b16 a[228:229], v22 offset:8192
 ds_read_b64_tr_b16 a[230:231], v22 offset:8704
 v_mfma_f32_32x32x16_bf16 v[208:223], a[244:247], a[100:103], v[208:223]
 ds_read_b64_tr_b16 a[232:233], v23 offset:8192
 ds_read_b64_tr_b16 a[234:235], v23 offset:8704
 s_waitcnt lgkmcnt(6)
 v_mfma_f32_32x32x16_bf16 v[224:239], a[248:251], a[100:103], v[224:239]
 ds_read_b128 a[236:239], v14 offset:832
 v_mfma_f32_32x32x16_bf16 v[240:255], a[252:255], a[100:103], v[240:255]
 ds_read_b64_tr_b16 a[240:241], v21 offset:12288
 ds_read_b64_tr_b16 a[242:243], v21 offset:12800
 s_waitcnt lgkmcnt(5)
 v_mfma_f32_32x32x16_bf16 v[192:207], a[224:227], a[104:107], v[192:207]
 ds_read_b64_tr_b16 a[244:245], v22 offset:12288
 ds_read_b64_tr_b16 a[246:247], v22 offset:12800
 v_mfma_f32_32x32x16_bf16 v[208:223], a[228:231], a[104:107], v[208:223]
 ds_read_b64_tr_b16 a[248:249], v23 offset:12288
 ds_read_b64_tr_b16 a[250:251], v23 offset:12800
 s_waitcnt lgkmcnt(6)
 v_mfma_f32_32x32x16_bf16 v[224:239], a[232:235], a[104:107], v[224:239]
 ds_read_b128 a[252:255], v14 offset:864
 v_mfma_f32_32x32x16_bf16 v[240:255], a[236:239], a[104:107], v[240:255]
 s_waitcnt lgkmcnt(3)
 v_mfma_f32_32x32x16_bf16 v[192:207], a[240:243], a[108:111], v[192:207]
 v_mfma_f32_32x32x16_bf16 v[208:223], a[244:247], a[108:111], v[208:223]
 s_waitcnt lgkmcnt(0)
 v_mfma_f32_32x32x16_bf16 v[224:239], a[248:251], a[108:111], v[224:239]
 v_mfma_f32_32x32x16_bf16 v[240:255], a[252:255], a[108:111], v[240:255]
 s_nop 7
 v_fmamk_f32 v36, v192, 0x3fb8aa3b, v91
 v_fmamk_f32 v37, v193, 0x3fb8aa3b, v91
 v_fmamk_f32 v38, v194, 0x3fb8aa3b, v91
 v_fmamk_f32 v39, v195, 0x3fb8aa3b, v91
 v_exp_f32_e64 v36, v36 clamp
 v_max_f32 v192, s89, v192
 v_exp_f32_e64 v37, v37 clamp
 v_max_f32 v193, s89, v193
 v_exp_f32_e64 v38, v38 clamp
 v_max_f32 v194, s89, v194
 v_exp_f32_e64 v39, v39 clamp
 v_max_f32 v195, s89, v195
 v_mul_f32 v60, 0xbfb8aa3b, v240
 v_add_f32 v192, v192, v36
 v_add_f32 v193, v193, v37
 v_exp_f32 v60, v60
 v_add_f32 v194, v194, v38
 v_add_f32 v195, v195, v39
 v_add_f32 v60, 1.0, v60
 v_fmamk_f32 v36, v196, 0x3fb8aa3b, v91
 v_fmamk_f32 v37, v197, 0x3fb8aa3b, v91
 buffer_load_dword v68, v86, s[44:47], 0 offen sc1
 v_rcp_f32 v60, v60
 v_fmamk_f32 v38, v198, 0x3fb8aa3b, v91
 v_fmamk_f32 v39, v199, 0x3fb8aa3b, v91
 v_sub_f32 v61, 1.0, v60
 v_exp_f32_e64 v36, v36 clamp
 v_max_f32 v196, s89, v196
 v_exp_f32_e64 v37, v37 clamp
 v_max_f32 v197, s89, v197
 v_exp_f32_e64 v38, v38 clamp
 v_max_f32 v198, s89, v198
 v_exp_f32_e64 v39, v39 clamp
 v_max_f32 v199, s89, v199
 v_add_f32 v196, v196, v36
 v_add_f32 v197, v197, v37
 v_add_f32 v198, v198, v38
 v_add_f32 v199, v199, v39
 v_fmamk_f32 v36, v200, 0x3fb8aa3b, v91
 v_fmamk_f32 v37, v201, 0x3fb8aa3b, v91
 v_fmamk_f32 v38, v202, 0x3fb8aa3b, v91
 v_fmamk_f32 v39, v203, 0x3fb8aa3b, v91
 v_exp_f32_e64 v36, v36 clamp
 v_max_f32 v200, s89, v200
 v_exp_f32_e64 v37, v37 clamp
 v_max_f32 v201, s89, v201
 v_exp_f32_e64 v38, v38 clamp
 v_max_f32 v202, s89, v202
 v_exp_f32_e64 v39, v39 clamp
 v_max_f32 v203, s89, v203
 v_add_f32 v200, v200, v36
 v_add_f32 v201, v201, v37
 v_add_f32 v202, v202, v38
 v_add_f32 v203, v203, v39
 v_fmamk_f32 v36, v204, 0x3fb8aa3b, v91
 v_fmamk_f32 v37, v205, 0x3fb8aa3b, v91
 v_fmamk_f32 v38, v206, 0x3fb8aa3b, v91
 v_fmamk_f32 v39, v207, 0x3fb8aa3b, v91
 v_exp_f32_e64 v36, v36 clamp
 v_max_f32 v204, s89, v204
 v_exp_f32_e64 v37, v37 clamp
 v_max_f32 v205, s89, v205
 v_exp_f32_e64 v38, v38 clamp
 v_max_f32 v206, s89, v206
 v_exp_f32_e64 v39, v39 clamp
 v_max_f32 v207, s89, v207
 v_add_f32 v204, v204, v36
 v_add_f32 v205, v205, v37
 v_add_f32 v206, v206, v38
 v_add_f32 v207, v207, v39
 v_cvt_pk_bf16_f32 v160, v192, v193
 v_cvt_pk_bf16_f32 v161, v194, v195
 v_cvt_pk_bf16_f32 v162, v196, v197
 v_cvt_pk_bf16_f32 v163, v198, v199
 v_cvt_pk_bf16_f32 v164, v200, v201
 v_cvt_pk_bf16_f32 v165, v202, v203
 v_cvt_pk_bf16_f32 v166, v204, v205
 v_cvt_pk_bf16_f32 v167, v206, v207
 v_fmamk_f32 v36, v208, 0x3fb8aa3b, v91
 v_fmamk_f32 v37, v209, 0x3fb8aa3b, v91
 v_fmamk_f32 v38, v210, 0x3fb8aa3b, v91
 v_fmamk_f32 v39, v211, 0x3fb8aa3b, v91
 v_exp_f32_e64 v36, v36 clamp
 v_max_f32 v208, s89, v208
 v_exp_f32_e64 v37, v37 clamp
 v_max_f32 v209, s89, v209
 v_exp_f32_e64 v38, v38 clamp
 v_max_f32 v210, s89, v210
 v_exp_f32_e64 v39, v39 clamp
 v_max_f32 v211, s89, v211
 v_add_f32 v208, v208, v36
 v_add_f32 v209, v209, v37
 v_add_f32 v210, v210, v38
 v_add_f32 v211, v211, v39
 v_fmamk_f32 v36, v212, 0x3fb8aa3b, v91
 v_fmamk_f32 v37, v213, 0x3fb8aa3b, v91
 v_fmamk_f32 v38, v214, 0x3fb8aa3b, v91
 v_fmamk_f32 v39, v215, 0x3fb8aa3b, v91
 v_exp_f32_e64 v36, v36 clamp
 v_max_f32 v212, s89, v212
 v_exp_f32_e64 v37, v37 clamp
 v_max_f32 v213, s89, v213
 v_exp_f32_e64 v38, v38 clamp
 v_max_f32 v214, s89, v214
 v_exp_f32_e64 v39, v39 clamp
 v_max_f32 v215, s89, v215
 v_add_f32 v212, v212, v36
 v_add_f32 v213, v213, v37
 v_add_f32 v214, v214, v38
 v_add_f32 v215, v215, v39
 v_fmamk_f32 v36, v216, 0x3fb8aa3b, v91
 v_fmamk_f32 v37, v217, 0x3fb8aa3b, v91
 v_fmamk_f32 v38, v218, 0x3fb8aa3b, v91
 v_fmamk_f32 v39, v219, 0x3fb8aa3b, v91
 v_exp_f32_e64 v36, v36 clamp
 v_max_f32 v216, s89, v216
 v_exp_f32_e64 v37, v37 clamp
 v_max_f32 v217, s89, v217
 v_exp_f32_e64 v38, v38 clamp
 v_max_f32 v218, s89, v218
 v_exp_f32_e64 v39, v39 clamp
 v_max_f32 v219, s89, v219
 s_waitcnt vmcnt(0)
 v_cmp_lt_u32 vcc, 0, v68
 s_nop 0
 s_cmp_eq_u64 vcc, -1
 s_cbranch_scc0 L_spin_K
L_ok_K:
 s_add_u32 m0, s55, 0
 s_add_u32 s88, s52, 0
 buffer_load_dwordx4 v2, s[44:47], s88 offen offset:0 sc1 lds
 buffer_load_dwordx4 v2, s[44:47], s88 offen offset:1024 sc1 lds
 buffer_load_dwordx4 v2, s[44:47], s88 offen offset:2048 sc1 lds
 buffer_load_dwordx4 v2, s[44:47], s88 offen offset:3072 sc1 lds
 s_add_u32 m0, s55, 4096
 s_add_u32 s88, s52, 4096
 buffer_load_dwordx4 v2, s[44:47], s88 offen offset:0 sc1 lds
 buffer_load_dwordx4 v2, s[44:47], s88 offen offset:1024 sc1 lds
 buffer_load_dwordx4 v2, s[44:47], s88 offen offset:2048 sc1 lds
 buffer_load_dwordx4 v2, s[44:47], s88 offen offset:3072 sc1 lds
 v_add_f32 v216, v216, v36
 v_add_f32 v217, v217, v37
 v_add_f32 v218, v218, v38
 v_add_f32 v219, v219, v39
 v_fmamk_f32 v36, v220, 0x3fb8aa3b, v91
 v_fmamk_f32 v37, v221, 0x3fb8aa3b, v91
 v_fmamk_f32 v38, v222, 0x3fb8aa3b, v91
 v_fmamk_f32 v39, v223, 0x3fb8aa3b, v91
 v_exp_f32_e64 v36, v36 clamp
 v_max_f32 v220, s89, v220
 v_exp_f32_e64 v37, v37 clamp
 v_max_f32 v221, s89, v221
 v_exp_f32_e64 v38, v38 clamp
 v_max_f32 v222, s89, v222
 v_exp_f32_e64 v39, v39 clamp
 v_max_f32 v223, s89, v223
 v_add_f32 v220, v220, v36
 v_add_f32 v221, v221, v37
 v_add_f32 v222, v222, v38
 v_add_f32 v223, v223, v39
 v_cvt_pk_bf16_f32 v168, v208, v209
 v_cvt_pk_bf16_f32 v169, v210, v211
 v_cvt_pk_bf16_f32 v170, v212, v213
 v_cvt_pk_bf16_f32 v171, v214, v215
 v_cvt_pk_bf16_f32 v172, v216, v217
 v_cvt_pk_bf16_f32 v173, v218, v219
 v_cvt_pk_bf16_f32 v174, v220, v221
 v_cvt_pk_bf16_f32 v175, v222, v223
 v_fmamk_f32 v36, v224, 0x3fb8aa3b, v91
 v_fmamk_f32 v37, v225, 0x3fb8aa3b, v91
 v_fmamk_f32 v38, v226, 0x3fb8aa3b, v91
 v_fmamk_f32 v39, v227, 0x3fb8aa3b, v91
 v_exp_f32_e64 v36, v36 clamp
 v_max_f32 v224, s89, v224
 v_exp_f32_e64 v37, v37 clamp
 v_max_f32 v225, s89, v225
 v_exp_f32_e64 v38, v38 clamp
 v_max_f32 v226, s89, v226
 v_exp_f32_e64 v39, v39 clamp
 v_max_f32 v227, s89, v227
 v_add_f32 v224, v224, v36
 v_add_f32 v225, v225, v37
 v_add_f32 v226, v226, v38
 v_add_f32 v227, v227, v39
 v_fmamk_f32 v36, v228, 0x3fb8aa3b, v91
 v_fmamk_f32 v37, v229, 0x3fb8aa3b, v91
 v_fmamk_f32 v38, v230, 0x3fb8aa3b, v91
 v_fmamk_f32 v39, v231, 0x3fb8aa3b, v91
 v_exp_f32_e64 v36, v36 clamp
 v_max_f32 v228, s89, v228
 v_exp_f32_e64 v37, v37 clamp
 v_max_f32 v229, s89, v229
 v_exp_f32_e64 v38, v38 clamp
 v_max_f32 v230, s89, v230
 v_exp_f32_e64 v39, v39 clamp
 v_max_f32 v231, s89, v231
 v_add_f32 v228, v228, v36
 v_add_f32 v229, v229, v37
 v_add_f32 v230, v230, v38
 v_add_f32 v231, v231, v39
 v_fmamk_f32 v36, v232, 0x3fb8aa3b, v91
 v_fmamk_f32 v37, v233, 0x3fb8aa3b, v91
 v_fmamk_f32 v38, v234, 0x3fb8aa3b, v91
 v_fmamk_f32 v39, v235, 0x3fb8aa3b, v91
 v_exp_f32_e64 v36, v36 clamp
 v_max_f32 v232, s89, v232
 v_exp_f32_e64 v37, v37 clamp
 v_max_f32 v233, s89, v233
 v_exp_f32_e64 v38, v38 clamp
 v_max_f32 v234, s89, v234
 v_exp_f32_e64 v39, v39 clamp
 v_max_f32 v235, s89, v235
 v_add_f32 v232, v232, v36
 v_add_f32 v233, v233, v37
 v_add_f32 v234, v234, v38
 v_add_f32 v235, v235, v39
 v_fmamk_f32 v36, v236, 0x3fb8aa3b, v91
 v_fmamk_f32 v37, v237, 0x3fb8aa3b, v91
 v_fmamk_f32 v38, v238, 0x3fb8aa3b, v91
 v_fmamk_f32 v39, v239, 0x3fb8aa3b, v91
 v_exp_f32_e64 v36, v36 clamp
 v_max_f32 v236, s89, v236
 v_exp_f32_e64 v37, v37 clamp
 v_max_f32 v237, s89, v237
 v_exp_f32_e64 v38, v38 clamp
 v_max_f32 v238, s89, v238
 v_exp_f32_e64 v39, v39 clamp
 v_max_f32 v239, s89, v239
 v_add_f32 v236, v236, v36
 v_add_f32 v237, v237, v37
 v_add_f32 v238, v238, v38
 v_add_f32 v239, v239, v39
 buffer_store_dword v61, v33, s[44:47], s53 offen sc1
 s_waitcnt vmcnt(1)
 s_barrier
 ds_read_b128 a[0:3], v89 offset:0
 ds_read_b128 a[4:7], v89 offset:1024
 ds_read_b128 a[8:11], v89 offset:2048
 ds_read_b128 a[12:15], v89 offset:3072
 ds_read_b128 a[16:19], v89 offset:4096
 ds_read_b128 a[20:23], v89 offset:5120
 ds_read_b128 a[24:27], v89 offset:6144
 ds_read_b128 a[28:31], v89 offset:7168
 ds_read_b128 a[32:35], v89 offset:8192
 ds_read_b128 a[36:39], v89 offset:9216
 ds_read_b128 a[40:43], v89 offset:10240
 ds_read_b128 a[44:47], v89 offset:11264
 ds_read_b128 a[48:51], v89 offset:12288
 ds_read_b128 a[52:55], v89 offset:13312
 ds_read_b128 a[56:59], v89 offset:14336
 ds_read_b128 a[60:63], v89 offset:15360
 v_cvt_pk_bf16_f32 v176, v224, v225
 v_cvt_pk_bf16_f32 v177, v226, v227
 v_cvt_pk_bf16_f32 v178, v228, v229
 v_cvt_pk_bf16_f32 v179, v230, v231
 v_cvt_pk_bf16_f32 v180, v232, v233
 v_cvt_pk_bf16_f32 v181, v234, v235
 v_cvt_pk_bf16_f32 v182, v236, v237
 v_cvt_pk_bf16_f32 v183, v238, v239
 s_waitcnt lgkmcnt(12)
 v_mfma_f32_32x32x16_bf16 v[192:207], a[0:3], v[128:131], 0
 ds_read_b128 a[64:67], v89 offset:16384
 ds_read_b128 a[68:71], v89 offset:17408
 ds_read_b128 a[72:75], v89 offset:18432
 ds_read_b128 a[76:79], v89 offset:19456
 v_mfma_f32_32x32x16_bf16 v[192:207], a[4:7], v[132:135], v[192:207]
 ds_read_b128 a[80:83], v89 offset:20480
 ds_read_b128 a[84:87], v89 offset:21504
 ds_read_b128 a[88:91], v89 offset:22528
 ds_read_b128 a[92:95], v89 offset:23552
 v_mfma_f32_32x32x16_bf16 v[192:207], a[8:11], v[128:131], v[192:207]
 ds_read_b128 a[96:99], v89 offset:24576
 ds_read_b128 a[100:103], v89 offset:25600
 ds_read_b128 a[104:107], v89 offset:26624
 ds_read_b128 a[108:111], v89 offset:27648
 v_mfma_f32_32x32x16_bf16 v[192:207], a[12:15], v[132:135], v[192:207]
 ds_read_b128 a[112:115], v89 offset:28672
 ds_read_b128 a[116:119], v89 offset:29696
 ds_read_b128 a[120:123], v89 offset:30720
 ds_read_b128 a[124:127], v89 offset:31744
 s_waitcnt lgkmcnt(14)
 v_mfma_f32_32x32x16_bf16 v[208:223], a[16:19], v[134:137], 0
 v_mfma_f32_32x32x16_bf16 v[208:223], a[20:23], v[138:141], v[208:223]
 s_nop 4
 v_add_f32 v36, s89, v204
 v_add_f32 v37, s89, v204
 s_nop 1
 v_permlane32_swap_b32 v36, v37
 v_rcp_f32 v38, v37
 s_nop 0
 v_mul_f32 v36, v38, v60
 v_mfma_f32_32x32x16_bf16 v[208:223], a[24:27], v[134:137], v[208:223]
 v_mul_f32 v192, v192, v36
 v_mul_f32 v193, v193, v36
 v_mul_f32 v194, v194, v36
 v_mfma_f32_32x32x16_bf16 v[208:223], a[28:31], v[138:141], v[208:223]
 v_mul_f32 v195, v195, v36
 v_mul_f32 v196, v196, v36
 v_mul_f32 v197, v197, v36
 v_mul_f32 v198, v198, v36
 v_mul_f32 v199, v199, v36
 v_mul_f32 v200, v200, v36
 v_mul_f32 v201, v201, v36
 v_mul_f32 v202, v202, v36
 v_mfma_f32_32x32x16_bf16 v[224:239], a[32:35], v[142:145], 0
 v_mul_f32 v203, v203, v36
 v_mul_f32 v204, v204, v36
 v_mul_f32 v205, v205, v36
 v_mul_f32 v206, v206, v36
 v_add_f32 v40, s89, v208
 v_mul_f32 v207, v207, v36
 v_add_f32 v41, s89, v208
 v_cvt_pk_bf16_f32 v128, v192, v193
 v_cvt_pk_bf16_f32 v129, v194, v195
 v_mfma_f32_32x32x16_bf16 v[224:239], a[36:39], v[146:149], v[224:239]
 v_cvt_pk_bf16_f32 v130, v196, v197
 v_permlane32_swap_b32 v40, v41
 v_cvt_pk_bf16_f32 v131, v198, v199
 v_cvt_pk_bf16_f32 v132, v200, v201
 v_rcp_f32 v42, v40
 v_cvt_pk_bf16_f32 v133, v202, v203
 v_cvt_pk_bf16_f32 v134, v204, v205
 v_mul_f32 v40, v42, v60
 v_cvt_pk_bf16_f32 v135, v206, v207
 v_mfma_f32_32x32x16_bf16 v[224:239], a[40:43], v[142:145], v[224:239]
 s_mov_b32 s88, 0
 buffer_store_dwordx4 v[128:131], v8, s[44:47], s88 offen sc1
 v_mul_f32 v208, v208, v40
 v_mul_f32 v209, v209, v40
 v_mul_f32 v210, v210, v40
 v_mfma_f32_32x32x16_bf16 v[224:239], a[44:47], v[146:149], v[224:239]
 v_mul_f32 v211, v211, v40
 v_mul_f32 v212, v212, v40
 v_mul_f32 v213, v213, v40
 v_mul_f32 v214, v214, v40
 v_mul_f32 v215, v215, v40
 v_mul_f32 v216, v216, v40
 v_mul_f32 v217, v217, v40
 v_mul_f32 v218, v218, v40
 v_mfma_f32_32x32x16_bf16 v[240:255], a[48:51], v[148:151], 0
 v_mul_f32 v219, v219, v40
 v_mul_f32 v220, v220, v40
 v_mul_f32 v221, v221, v40
 v_mul_f32 v222, v222, v40
 v_add_f32 v36, s89, v236
 v_mul_f32 v223, v223, v40
 v_add_f32 v37, s89, v236
 v_cvt_pk_bf16_f32 v64, v208, v209
 v_cvt_pk_bf16_f32 v65, v210, v211
 v_mfma_f32_32x32x16_bf16 v[240:255], a[52:55], v[152:155], v[240:255]
 v_cvt_pk_bf16_f32 v136, v212, v213
 v_permlane32_swap_b32 v36, v37
 v_cvt_pk_bf16_f32 v137, v214, v215
 v_cvt_pk_bf16_f32 v138, v216, v217
 v_rcp_f32 v38, v37
 v_cvt_pk_bf16_f32 v139, v218, v219
 v_cvt_pk_bf16_f32 v140, v220, v221
 v_mul_f32 v36, v38, v60
 v_cvt_pk_bf16_f32 v141, v222, v223
 v_cndmask_b32_e64 v134, v134, v64, s[96:97]
 v_cndmask_b32_e64 v135, v135, v65, s[96:97]
 s_waitcnt lgkmcnt(12)
 v_mfma_f32_32x32x16_bf16 v[240:255], a[56:59], v[148:151], v[240:255]
 s_mov_b32 s88, 2048
 buffer_store_dwordx4 v[132:135], v8, s[44:47], s88 offen sc1
 v_mul_f32 v224, v224, v36
 v_mul_f32 v225, v225, v36
 v_mul_f32 v226, v226, v36
 v_mfma_f32_32x32x16_bf16 v[240:255], a[60:63], v[152:155], v[240:255]
 s_mov_b32 s88, 4096
 buffer_store_dwordx4 v[136:139], v8, s[44:47], s88 offen sc1
 v_mul_f32 v227, v227, v36
 v_mul_f32 v228, v228, v36
 v_mul_f32 v229, v229, v36
 v_mul_f32 v230, v230, v36
 v_mul_f32 v231, v231, v36
 v_mul_f32 v232, v232, v36
 v_mul_f32 v233, v233, v36
 v_mul_f32 v234, v234, v36
 v_mfma_f32_32x32x16_bf16 v[192:207], a[64:67], v[156:159], 0
 v_mul_f32 v235, v235, v36
 v_mul_f32 v236, v236, v36
 v_mul_f32 v237, v237, v36
 v_mul_f32 v238, v238, v36
 v_add_f32 v40, s89, v240
 v_mul_f32 v239, v239, v36
 v_add_f32 v41, s89, v240
 v_cvt_pk_bf16_f32 v142, v224, v225
 v_cvt_pk_bf16_f32 v143, v226, v227
 v_mfma_f32_32x32x16_bf16 v[192:207], a[68:71], v[160:163], v[192:207]
 v_cvt_pk_bf16_f32 v144, v228, v229
 v_permlane32_swap_b32 v40, v41
 v_cvt_pk_bf16_f32 v145, v230, v231
 v_cvt_pk_bf16_f32 v146, v232, v233
 v_rcp_f32 v42, v40
 v_cvt_pk_bf16_f32 v147, v234, v235
 v_cvt_pk_bf16_f32 v148, v236, v237
 v_mul_f32 v40, v42, v60
 v_cvt_pk_bf16_f32 v149, v238, v239
 s_waitcnt lgkmcnt(8)
 v_mfma_f32_32x32x16_bf16 v[192:207], a[72:75], v[156:159], v[192:207]
 s_mov_b32 s88, 6144
 buffer_store_dwordx4 v[140:143], v8, s[44:47], s88 offen sc1
 v_mul_f32 v240, v240, v40
 v_mul_f32 v241, v241, v40
 v_mul_f32 v242, v242, v40
 v_mfma_f32_32x32x16_bf16 v[192:207], a[76:79], v[160:163], v[192:207]
 s_mov_b32 s88, 8192
 buffer_store_dwordx4 v[144:147], v8, s[44:47], s88 offen sc1
 v_mul_f32 v243, v243, v40
 v_mul_f32 v244, v244, v40
 v_mul_f32 v245, v245, v40
 v_mul_f32 v246, v246, v40
 v_mul_f32 v247, v247, v40
 v_mul_f32 v248, v248, v40
 v_mul_f32 v249, v249, v40
 v_mul_f32 v250, v250, v40
 v_mfma_f32_32x32x16_bf16 v[208:223], a[80:83], v[162:165], 0
 v_mul_f32 v251, v251, v40
 v_mul_f32 v252, v252, v40
 v_mul_f32 v253, v253, v40
 v_mul_f32 v254, v254, v40
 v_add_f32 v36, s89, v204
 v_mul_f32 v255, v255, v40
 v_add_f32 v37, s89, v204
 v_cvt_pk_bf16_f32 v64, v240, v241
 v_cvt_pk_bf16_f32 v65, v242, v243
 v_mfma_f32_32x32x16_bf16 v[208:223], a[84:87], v[166:169], v[208:223]
 v_cvt_pk_bf16_f32 v150, v244, v245
 v_permlane32_swap_b32 v36, v37
 v_cvt_pk_bf16_f32 v151, v246, v247
 v_cvt_pk_bf16_f32 v152, v248, v249
 v_rcp_f32 v38, v37
 v_cvt_pk_bf16_f32 v153, v250, v251
 v_cvt_pk_bf16_f32 v154, v252, v253
 v_mul_f32 v36, v38, v60
 v_cvt_pk_bf16_f32 v155, v254, v255
 v_cndmask_b32_e64 v148, v148, v64, s[96:97]
 v_cndmask_b32_e64 v149, v149, v65, s[96:97]
 s_waitcnt lgkmcnt(4)
 v_mfma_f32_32x32x16_bf16 v[208:223], a[88:91], v[162:165], v[208:223]
 s_mov_b32 s88, 10240
 buffer_store_dwordx4 v[148:151], v8, s[44:47], s88 offen sc1
 v_mul_f32 v192, v192, v36
 v_mul_f32 v193, v193, v36
 v_mul_f32 v194, v194, v36
 v_mfma_f32_32x32x16_bf16 v[208:223], a[92:95], v[166:169], v[208:223]
 s_mov_b32 s88, 12288
 buffer_store_dwordx4 v[152:155], v8, s[44:47], s88 offen sc1
 v_mul_f32 v195, v195, v36
 v_mul_f32 v196, v196, v36
 v_mul_f32 v197, v197, v36
 v_mul_f32 v198, v198, v36
 v_mul_f32 v199, v199, v36
 v_mul_f32 v200, v200, v36
 v_mul_f32 v201, v201, v36
 v_mul_f32 v202, v202, v36
 v_mfma_f32_32x32x16_bf16 v[224:239], a[96:99], v[170:173], 0
 v_mul_f32 v203, v203, v36
 v_mul_f32 v204, v204, v36
 v_mul_f32 v205, v205, v36
 v_mul_f32 v206, v206, v36
 v_add_f32 v40, s89, v208
 v_mul_f32 v207, v207, v36
 v_add_f32 v41, s89, v208
 v_cvt_pk_bf16_f32 v156, v192, v193
 v_cvt_pk_bf16_f32 v157, v194, v195
 v_mfma_f32_32x32x16_bf16 v[224:239], a[100:103], v[174:177], v[224:239]
 v_cvt_pk_bf16_f32 v158, v196, v197
 v_permlane32_swap_b32 v40, v41
 v_cvt_pk_bf16_f32 v159, v198, v199
 v_cvt_pk_bf16_f32 v160, v200, v201
 v_rcp_f32 v42, v40
 v_cvt_pk_bf16_f32 v161, v202, v203
 v_cvt_pk_bf16_f32 v162, v204, v205
 v_mul_f32 v40, v42, v60
 v_cvt_pk_bf16_f32 v163, v206, v207
 s_waitcnt lgkmcnt(0)
 v_mfma_f32_32x32x16_bf16 v[224:239], a[104:107], v[170:173], v[224:239]
 s_mov_b32 s88, 73728
 buffer_store_dwordx4 v[156:159], v8, s[44:47], s88 offen sc1
 v_mul_f32 v208, v208, v40
 v_mul_f32 v209, v209, v40
 v_mul_f32 v210, v210, v40
 v_mfma_f32_32x32x16_bf16 v[224:239], a[108:111], v[174:177], v[224:239]
 v_mul_f32 v211, v211, v40
 v_mul_f32 v212, v212, v40
 v_mul_f32 v213, v213, v40
 v_mul_f32 v214, v214, v40
 v_mul_f32 v215, v215, v40
 v_mul_f32 v216, v216, v40
 v_mul_f32 v217, v217, v40
 v_mul_f32 v218, v218, v40
 v_mfma_f32_32x32x16_bf16 v[240:255], a[112:115], v[176:179], 0
 v_mul_f32 v219, v219, v40
 v_mul_f32 v220, v220, v40
 v_mul_f32 v221, v221, v40
 v_mul_f32 v222, v222, v40
 v_add_f32 v36, s89, v236
 v_mul_f32 v223, v223, v40
 v_add_f32 v37, s89, v236
 v_cvt_pk_bf16_f32 v64, v208, v209
 v_cvt_pk_bf16_f32 v65, v210, v211
 v_mfma_f32_32x32x16_bf16 v[240:255], a[116:119], v[180:183], v[240:255]
 v_cvt_pk_bf16_f32 v164, v212, v213
 v_permlane32_swap_b32 v36, v37
 v_cvt_pk_bf16_f32 v165, v214, v215
 v_cvt_pk_bf16_f32 v166, v216, v217
 v_rcp_f32 v38, v37
 v_cvt_pk_bf16_f32 v167, v218, v219
 v_cvt_pk_bf16_f32 v168, v220, v221
 v_mul_f32 v36, v38, v60
 v_cvt_pk_bf16_f32 v169, v222, v223
 v_cndmask_b32_e64 v162, v162, v64, s[96:97]
 v_cndmask_b32_e64 v163, v163, v65, s[96:97]
 v_mfma_f32_32x32x16_bf16 v[240:255], a[120:123], v[176:179], v[240:255]
 s_mov_b32 s88, 75776
 buffer_store_dwordx4 v[160:163], v8, s[44:47], s88 offen sc1
 v_mul_f32 v224, v224, v36
 v_mul_f32 v225, v225, v36
 v_mul_f32 v226, v226, v36
 v_mfma_f32_32x32x16_bf16 v[240:255], a[124:127], v[180:183], v[240:255]
 s_mov_b32 s88, 77824
 buffer_store_dwordx4 v[164:167], v8, s[44:47], s88 offen sc1
 v_mul_f32 v227, v227, v36
 v_mul_f32 v228, v228, v36
 v_mul_f32 v229, v229, v36
 v_mul_f32 v230, v230, v36
 v_mul_f32 v231, v231, v36
 v_mul_f32 v232, v232, v36
 v_mul_f32 v233, v233, v36
 v_mul_f32 v234, v234, v36
 v_mul_f32 v235, v235, v36
 v_mul_f32 v236, v236, v36
 v_mul_f32 v237, v237, v36
 v_mul_f32 v238, v238, v36
 v_add_f32 v40, s89, v240
 v_mul_f32 v239, v239, v36
 v_add_f32 v41, s89, v240
 v_cvt_pk_bf16_f32 v170, v224, v225
 v_cvt_pk_bf16_f32 v171, v226, v227
 v_cvt_pk_bf16_f32 v172, v228, v229
 v_permlane32_swap_b32 v40, v41
 v_cvt_pk_bf16_f32 v173, v230, v231
 v_cvt_pk_bf16_f32 v174, v232, v233
 v_rcp_f32 v42, v40
 v_cvt_pk_bf16_f32 v175, v234, v235
 v_cvt_pk_bf16_f32 v176, v236, v237
 v_mul_f32 v40, v42, v60
 v_cvt_pk_bf16_f32 v177, v238, v239
 s_mov_b32 s88, 79872
 buffer_store_dwordx4 v[168:171], v8, s[44:47], s88 offen sc1
 v_mul_f32 v240, v240, v40
 v_mul_f32 v241, v241, v40
 v_mul_f32 v242, v242, v40
 s_mov_b32 s88, 81920
 buffer_store_dwordx4 v[172:175], v8, s[44:47], s88 offen sc1
 v_mul_f32 v243, v243, v40
 v_mul_f32 v244, v244, v40
 v_mul_f32 v245, v245, v40
 v_mul_f32 v246, v246, v40
 v_mul_f32 v247, v247, v40
 v_mul_f32 v248, v248, v40
 v_mul_f32 v249, v249, v40
 v_mul_f32 v250, v250, v40
 v_mul_f32 v251, v251, v40
 v_mul_f32 v252, v252, v40
 v_mul_f32 v253, v253, v40
 v_mul_f32 v254, v254, v40
 v_mul_f32 v255, v255, v40
 v_cvt_pk_bf16_f32 v64, v240, v241
 v_cvt_pk_bf16_f32 v65, v242, v243
 v_cvt_pk_bf16_f32 v178, v244, v245
 v_cvt_pk_bf16_f32 v179, v246, v247
 v_cvt_pk_bf16_f32 v180, v248, v249
 v_cvt_pk_bf16_f32 v181, v250, v251
 v_cvt_pk_bf16_f32 v182, v252, v253
 v_cvt_pk_bf16_f32 v183, v254, v255
 v_cndmask_b32_e64 v176, v176, v64, s[96:97]
 v_cndmask_b32_e64 v177, v177, v65, s[96:97]
 s_mov_b32 s88, 83968
 buffer_store_dwordx4 v[176:179], v8, s[44:47], s88 offen sc1
 s_mov_b32 s88, 86016
 buffer_store_dwordx4 v[180:183], v8, s[44:47], s88 offen sc1
 s_waitcnt vmcnt(0)
 buffer_store_dword v12, v33, s[44:47], s27 offen sc1
L_end:
 s_endpgm
L_spin_z2:
 s_mov_b32 s85, 0
L_spin2_z2:
 s_sleep 2
 buffer_load_dword v13, v59, s[48:51], 0 offen sc1
 s_add_u32 s85, s85, 1
 s_waitcnt vmcnt(0)
 v_cmp_lt_u32 vcc, 0, v13
 s_nop 1
 s_cmp_eq_u64 vcc, -1
 s_cbranch_scc1 L_ok_z2
 s_cmp_lt_u32 s85, 100000
 s_cbranch_scc1 L_spin2_z2
 s_branch L_ok_z2
L_spin_A:
 s_mov_b32 s85, 0
L_spin2_A:
 s_sleep 2
 buffer_load_dword v68, v78, s[44:47], 0 offen sc1
 s_add_u32 s85, s85, 1
 s_waitcnt vmcnt(0)
 v_cmp_lt_u32 vcc, 1, v68
 s_nop 1
 s_cmp_eq_u64 vcc, -1
 s_cbranch_scc1 L_ok_A
 s_cmp_lt_u32 s85, 100000
 s_cbranch_scc1 L_spin2_A
 s_branch L_ok_A
L_spin_B:
 s_mov_b32 s85, 0
L_spin2_B:
 s_sleep 2
 buffer_load_dword v68, v78, s[44:47], 0 offen sc1
 s_add_u32 s85, s85, 1
 s_waitcnt vmcnt(0)
 v_cmp_lt_u32 vcc, 2, v68
 s_nop 1
 s_cmp_eq_u64 vcc, -1
 s_cbranch_scc1 L_ok_B
 s_cmp_lt_u32 s85, 100000
 s_cbranch_scc1 L_spin2_B
 s_branch L_ok_B
L_spin_O:
 s_mov_b32 s85, 0
L_spin2_O:
 s_sleep 2
 buffer_load_dword v68, v79, s[44:47], 0 offen sc1
 s_add_u32 s85, s85, 1
 s_waitcnt vmcnt(0)
 v_cmp_lt_u32 vcc, 0, v68
 s_nop 1
 s_cmp_eq_u64 vcc, -1
 s_cbranch_scc1 L_ok_O
 s_cmp_lt_u32 s85, 100000
 s_cbranch_scc1 L_spin2_O
 s_branch L_ok_O
L_spin_z3:
 s_mov_b32 s85, 0
L_spin2_z3:
 s_sleep 2
 buffer_load_dword v13, v59, s[48:51], 0 offen sc1
 s_add_u32 s85, s85, 1
 s_waitcnt vmcnt(0)
 v_cmp_lt_u32 vcc, 0, v13
 s_nop 1
 s_cmp_eq_u64 vcc, -1
 s_cbranch_scc1 L_ok_z3
 s_cmp_lt_u32 s85, 100000
 s_cbranch_scc1 L_spin2_z3
 s_branch L_ok_z3
L_spin_P:
 s_mov_b32 s85, 0
L_spin2_P:
 s_sleep 2
 buffer_load_dword v68, v85, s[44:47], s99 offen sc1
 s_add_u32 s85, s85, 1
 s_waitcnt vmcnt(0)
 v_cmp_lt_u32 vcc, 0, v68
 s_nop 1
 s_cmp_eq_u64 vcc, -1
 s_cbranch_scc1 L_ok_P
 s_cmp_lt_u32 s85, 100000
 s_cbranch_scc1 L_spin2_P
 s_branch L_ok_P
L_spin_K:
 s_mov_b32 s85, 0
L_spin2_K:
 s_sleep 2
 buffer_load_dword v68, v86, s[44:47], 0 offen sc1
 s_add_u32 s85, s85, 1
 s_waitcnt vmcnt(0)
 v_cmp_lt_u32 vcc, 0, v68
 s_nop 1
 s_cmp_eq_u64 vcc, -1
 s_cbranch_scc1 L_ok_K
 s_cmp_lt_u32 s85, 100000
 s_cbranch_scc1 L_spin2_K
 s_branch L_ok_K
L_code_end:
 s_endpgm
.section .rodata,"a"
.p2align 6
.amdhsa_kernel gated_mix__linear_attn_block__glu_gated_reglu__prompt_kernel
  .amdhsa_next_free_vgpr 512
  .amdhsa_next_free_sgpr 102
  .amdhsa_accum_offset 256
  .amdhsa_group_segment_fixed_size 0
  .amdhsa_kernarg_size 88
  .amdhsa_user_sgpr_count 2
  .amdhsa_user_sgpr_kernarg_segment_ptr 1
  .amdhsa_system_sgpr_workgroup_id_x 1
  .amdhsa_float_denorm_mode_32 3
.end_amdhsa_kernel
```
